```python
import torch

def _softmax(x, axis=-1):
    return torch.softmax(x, dim=axis)
def _gelu(x):
    return torch.nn.functional.gelu(x, approximate="tanh")
def _silu(x):
    return torch.nn.functional.silu(x)
def _sigmoid(x):
    return torch.sigmoid(x)
def _layernorm(x, axis=-1, eps=1e-5):
    m = x.mean(dim=axis, keepdim=True)
    v = x.var(dim=axis, keepdim=True, unbiased=False)
    return (x - m) / torch.sqrt(v + eps)
def _scatter_add(tgt, idx, src, axis=0):
    return tgt.clone().index_add_(axis, idx, src)
def _segment_sum(src, seg, n):
    out = torch.zeros((n,) + src.shape[1:], dtype=src.dtype)
    return out.index_add_(0, seg, src)
def _pad(x, pw):
    flat = tuple(v for pair in reversed(pw) for v in pair)
    return torch.nn.functional.pad(x, flat)

kernel_name = 'concat_heads__ssm_conv_s4d__ssm_conv_h3__prompt'

def setup_inputs():

    _w = (lambda a: (lambda t: t.to(torch.bfloat16) if t.is_floating_point() else t)(torch.as_tensor(a)))
    def _A_setup():
        Bsz, L, D, N = 1, 2048, 448, 256
        return {
            "u": _w((lambda *s: torch.randn(*s, dtype=torch.bfloat16) * 0.05)(Bsz, L, D)),
            "log_A_real": _w((lambda *s: torch.randn(*s, dtype=torch.bfloat16) * 6.4)(D, N) * 0.5),
            "A_imag": _w((lambda *s: torch.randn(*s, dtype=torch.bfloat16) * 0.1)(D, N) * 3.14),
            "C_real": _w((lambda *s: torch.randn(*s, dtype=torch.bfloat16) * 0.2)(D, N) / N ** 0.5),
            "C_imag": _w((lambda *s: torch.randn(*s, dtype=torch.bfloat16) * 0.2)(D, N) / N ** 0.5),
            "log_dt": _w((lambda *s: torch.randn(*s, dtype=torch.bfloat16) * 0.1)(D) * 0.5 - 4.0),
            "D_skip": _w((lambda *s: torch.randn(*s, dtype=torch.bfloat16) * 0.1)(D)),
        }
    _A_in = _A_setup()

    def _B_setup():
        B, S, D = 1, 2048, 448
        ks = 4
        return {
            "q": _w((lambda *s: torch.randn(*s, dtype=torch.bfloat16) * 0.05)(B, S, D)),
            "k": _w((lambda *s: torch.randn(*s, dtype=torch.bfloat16) * 0.4)(B, S, D)),
            "v": _w((lambda *s: torch.randn(*s, dtype=torch.bfloat16) * 0.4)(B, S, D)),
            "shift_k": _w((lambda *s: torch.randn(*s, dtype=torch.bfloat16) * 0.4)(D, ks) * 0.5),
            "ssm_k": _w((lambda *s: torch.randn(*s, dtype=torch.bfloat16) * 0.4)(D, S) * (1.0 / S ** 0.5)),
            "ssm_D": _w((lambda *s: torch.randn(*s, dtype=torch.bfloat16) * 0.4)(D)),
        }
    _B_in = _B_setup()

    return {
        "A_u": _A_in["u"],
        "A_log_A_real": _A_in["log_A_real"],
        "A_A_imag": _A_in["A_imag"],
        "A_C_real": _A_in["C_real"],
        "A_C_imag": _A_in["C_imag"],
        "A_log_dt": _A_in["log_dt"],
        "A_D_skip": _A_in["D_skip"],
        "B_q": _B_in["q"],
        "B_k": _B_in["k"],
        "B_v": _B_in["v"],
        "B_shift_k": _B_in["shift_k"],
        "B_ssm_k": _B_in["ssm_k"],
        "B_ssm_D": _B_in["ssm_D"],
    }

def reference(A_u, A_log_A_real, A_A_imag, A_C_real, A_C_imag, A_log_dt, A_D_skip, B_q, B_k, B_v, B_shift_k, B_ssm_k, B_ssm_D):
    def _A_ref(u, log_A_real, A_imag, C_real, C_imag, log_dt, D_skip):
        L = u.shape[1]
        dt = torch.exp(log_dt)
        A = -torch.exp(log_A_real) + 1j * A_imag
        C = (C_real + 1j * C_imag) * dt[:, None]
        pos = (lambda x, dt: x.to(dt))(torch.arange(L), log_dt.dtype)
        P = torch.exp((A * dt[:, None])[:, :, None] * pos[None, None, :])
        K = 2.0 * torch.einsum("dn,dnl->dl", C, P).real
        L2 = 2 * L
        u_t = (lambda x, *d: x.permute(*d))(u, 0, 2, 1)
        Kf = (lambda x, *a, **k: torch.fft.rfft(x.float(), *a, **k))(K, L2)
        Uf = (lambda x, *a, **k: torch.fft.rfft(x.float(), *a, **k))(u_t, L2)
        y = (lambda x, *a, **k: torch.fft.irfft(x, *a, **k).to(torch.bfloat16))(Uf * Kf[None, :, :], L2)[:, :, :L]
        y = (lambda x, *d: x.permute(*d))(y, 0, 2, 1)
        return y + u * D_skip[None, None, :]

    def _B_ref(q, k, v, shift_k, ssm_k, ssm_D):
        B, S, D = q.shape
        ks = shift_k.shape[-1]
        k_pad = _pad(k, ((0, 0), (ks - 1, 0), (0, 0)))
        k_shift = torch.zeros_like(k)
        for t in range(ks):
            k_shift = k_shift + k_pad[:, t:t + S, :] * shift_k[:, ks - 1 - t][None, None, :]
        kv = k_shift * v
        L = 2 * S
        kv_pad = _pad(kv, ((0, 0), (0, S), (0, 0)))
        kf_pad = _pad(ssm_k, ((0, 0), (0, S)))
        kv_f = (lambda x, axes=(-2,-1): torch.fft.rfft2(x.float(), dim=axes))(kv_pad[:, None, :, :], axes=(1, 2))
        kf_f = (lambda x, axes=(-2,-1): torch.fft.rfft2(x.float(), dim=axes))(kf_pad[:, None, :], axes=(1, 2))
        kf_f = (lambda x, *d: x.permute(*d))(kf_f, 1, 2, 0)
        y_f = kv_f * kf_f[None, :, :, :]
        y = (lambda x, s, axes=(-2,-1): torch.fft.irfft2(x, s=s, dim=axes).to(torch.bfloat16))(y_f, (1, L), axes=(1, 2))[:, 0, :S, :]
        y = y + kv * ssm_D[None, None, :]
        return q * y

    a = _A_ref(A_u, A_log_A_real, A_A_imag, A_C_real, A_C_imag, A_log_dt, A_D_skip)
    b = _B_ref(B_q, B_k, B_v, B_shift_k, B_ssm_k, B_ssm_D)
    return torch.concatenate([a, b], axis=-1)
```

```asm
; @launch grid=(256,1,1) block=(512,1,1) lds=163760
.amdgcn_target "amdgcn-amd-amdhsa--gfx950"
.text
.globl concat_heads__ssm_conv_s4d__ssm_conv_h3__prompt_kernel
.p2align 8
.type concat_heads__ssm_conv_s4d__ssm_conv_h3__prompt_kernel,@function
concat_heads__ssm_conv_s4d__ssm_conv_h3__prompt_kernel:
    s_load_dwordx16 s[8:23], s[0:1], 0
    s_load_dwordx16 s[24:39], s[0:1], 64
    s_cmp_ge_u32 s2, 256
    s_cbranch_scc1 L_end
    s_and_b32 s4, s2, 7
    s_cmp_eq_u32 s4, 7
    s_cbranch_scc1 L_end
    s_getpc_b64 s[40:41]
L_pc:
    s_and_b32 s3, s2, 0xf8
    v_and_b32 v2, 7, v0
    v_add_u32 v2, s3, v2
    v_lshlrev_b32 v2, 7, v2
    v_min_u32 v2, L_codeend-L_pc-4, v2
    global_load_dword v255, v2, s[40:41]
    v_lshrrev_b32 v2, 6, v0
    v_and_b32 v1, 63, v0
    v_readfirstlane_b32 s7, v2
    s_lshr_b32 s3, s2, 3
    s_lshr_b32 s5, s3, 1
    s_lshl_b32 s6, s4, 4
    s_add_u32 s6, s6, s5
    s_and_b32 s94, s3, 1
    s_and_b32 s88, s7, 3
    s_lshr_b32 s89, s7, 2
    s_lshl_b32 s90, s6, 2
    s_add_u32 s90, s90, s88
    s_cmp_eq_u32 s94, 1
    s_cbranch_scc1 L_B
L_A:
    s_lshl_b32 s3, s90, 9
    s_lshl_b32 s42, s89, 8
    s_add_u32 s3, s3, s42
    v_lshl_add_u32 v4, v1, 2, s3
    s_lshl_b32 s42, s5, 7
    s_lshl_b32 s43, s7, 4
    s_add_u32 s42, s42, s43
    s_mul_i32 s42, s42, 896
    s_lshl_b32 s43, s4, 7
    s_add_u32 s42, s42, s43
    v_and_b32 v5, 15, v1
    v_mul_u32_u24 v5, 896, v5
    v_add_u32 v5, s42, v5
    s_lshr_b32 s3, s90, 1
    s_lshl_b32 s3, s3, 2
    s_waitcnt lgkmcnt(0)
    global_load_dword v16, v4, s[10:11] nt
    global_load_dword v17, v4, s[12:13] nt
    global_load_dword v18, v4, s[14:15] nt
    global_load_dword v19, v4, s[16:17] nt
    s_load_dword s91, s[18:19], s3
    s_load_dword s92, s[20:21], s3
    v_mov_b32 v168, v5
    s_mov_b32 s48, s8
    s_mov_b32 s49, s9
    s_mov_b32 s50, 1835008
    s_mov_b32 s51, 0x20000
    s_mov_b32 s44, s34
    s_mov_b32 s45, s35
    s_mov_b32 s46, 3670016
    s_mov_b32 s47, 0x20000
    s_mov_b32 s76, 0
    s_mov_b32 s77, 57344
    s_mov_b32 s78, 114688
    s_mov_b32 s79, 172032
    s_lshl_b32 s3, s6, 3
    s_mul_i32 s42, s7, 229376
    s_add_u32 s3, s3, s42
    v_mul_u32_u24 v24, 896, v1
    v_add_u32 v24, s3, v24
    s_mov_b32 s82, 0x05040100
    s_mov_b32 s83, 0x07060302
    v_add_u32 v7, -2688, v24
    s_mov_b32 s64, 0x3fb8aa3b
    s_mov_b32 s65, 0x32a57060
    s_mov_b32 s66, 0x3f317218
    s_mov_b32 s68, 0x41000000
    s_mov_b32 s70, 0x43800000
    s_mov_b32 s72, 0
    s_mov_b32 s73, -1
    s_mov_b32 s74, 0xaaaaaaaa
    s_mov_b32 s75, 0xaaaaaaaa
    s_lshl_b32 s3, s7, 8
    s_mov_b32 m0, s3
    v_and_b32 v2, 31, v1
    v_mul_u32_u24 v3, 2064, v2
    v_lshrrev_b32 v4, 5, v1
    v_lshl_add_u32 v4, v4, 4, s3
    v_add_u32 v166, v3, v4
    v_mov_b32 v5, 66048
    v_sub_u32 v3, v5, v3
    v_add_u32 v167, v3, v4
    v_lshl_add_u32 v2, v1, 2, s3
    v_add_u32 v2, v5, v2
    v_mov_b32 v52, 0x3f80
    ds_write_b32 v2, v52
    v_mov_b32 v56, 0
    v_mov_b32 v57, 0
    v_mov_b32 v58, 0
    v_mov_b32 v59, 0
    v_lshlrev_b32 v2, 4, v1
    v_add_u32 v2, 163728, v2
    s_mov_b64 exec, 3
    ds_write_b128 v2, v[56:59]
    s_mov_b64 exec, -1
    v_bfe_u32 v2, v1, 3, 2
    v_mul_u32_u24 v2, 16672, v2
    v_bfe_u32 v3, v1, 1, 2
    v_mul_u32_u24 v3, 4160, v3
    v_add_u32 v2, v2, v3
    v_and_b32 v3, 1, v1
    v_lshl_add_u32 v2, v3, 4, v2
    v_add_u32 v2, 68112, v2
    ds_write_b128 v2, v[56:59]
    global_load_dword v255, v168, s[8:9]
    s_lshl_b32 s3, s6, 14
    s_lshl_b32 s42, s7, 11
    s_add_u32 s3, s3, s42
    v_and_b32 v63, 15, v1
    v_lshl_add_u32 v63, v63, 7, s3
    s_mul_i32 s3, s7, 2080
    s_add_u32 s3, s3, 134800
    v_lshl_add_u32 v4, v1, 3, s3
    v_and_b32 v2, 3, v1
    v_bfe_u32 v3, v1, 2, 2
    v_lshrrev_b32 v62, 4, v1
    v_lshl_add_u32 v5, v2, 2, v3
    v_lshl_add_u32 v5, v62, 4, v5
    v_lshl_add_u32 v5, v5, 3, s3
    v_lshl_add_u32 v3, v62, 2, v3
    v_mul_u32_u24 v2, 16672, v2
    v_lshl_add_u32 v2, v3, 3, v2
    s_lshl_b32 s3, s7, 9
    s_add_u32 s3, s3, 68144
    v_add_u32 v6, s3, v2
    s_mul_i32 s3, s88, 4576
    s_add_u32 s3, s3, 1520
    v_lshlrev_b32 v2, 4, v1
    v_sub_u32 v174, s3, v2
    v_and_b32 v2, 31, v1
    v_lshlrev_b32 v2, 4, v2
    v_lshrrev_b32 v3, 5, v1
    v_lshl_add_u32 v2, v3, 3, v2
    s_add_u32 s3, s3, 2568
    v_sub_u32 v175, s3, v2
    s_mul_i32 s3, s88, 3072
    s_add_u32 s3, s3, 151440
    v_lshl_add_u32 v177, v1, 4, s3
    v_and_b32 v2, 15, v1
    v_lshrrev_b32 v3, 4, v1
    v_sub_u32 v62, 15, v2
    v_and_b32 v63, 3, v62
    v_mul_u32_u24 v63, 4160, v63
    v_lshrrev_b32 v62, 2, v62
    v_lshlrev_b32 v62, 3, v62
    v_sub_u32 v63, v63, v62
    v_lshl_add_u32 v63, v3, 4, v63
    s_mul_i32 s3, s88, 16672
    s_add_u32 s3, s3, 68144
    v_add_u32 v25, s3, v63
    v_lshlrev_b32 v62, 5, v2
    v_lshlrev_b32 v63, 4, v3
    v_sub_u32 v63, v63, v62
    s_mul_i32 s3, s88, 4576
    s_add_u32 s3, s3, 480
    v_add_u32 v26, s3, v63
    v_mul_u32_u24 v63, 144, v3
    v_lshl_add_u32 v63, v2, 3, v63
    s_mul_i32 s3, s88, 4672
    s_add_u32 s3, s3, 18304
    v_add_u32 v27, s3, v63
    s_lshl_b32 s3, s88, 2
    s_add_u32 s3, s3, 163728
    v_mov_b32 v28, s3
    v_mov_b32 v29, 1
    v_and_b32 v2, 3, v1
    v_lshlrev_b32 v2, 2, v2
    v_add_u32 v30, 163744, v2
    s_xor_b32 s3, s94, 1
    v_mov_b32 v31, s3
    s_and_b32 s3, s90, 1
    s_lshl_b32 s3, s3, 4
    s_waitcnt lgkmcnt(0)
    s_lshr_b32 s91, s91, s3
    s_lshl_b32 s91, s91, 16
    s_lshr_b32 s92, s92, s3
    s_lshl_b32 s92, s92, 16
    v_cmp_eq_u32 vcc, 0, v1
    v_mov_b32 v176, s92
    s_nop 0
    v_cndmask_b32 v176, 0, v176, vcc
    v_mov_b32 v48, s91
    v_mul_f32 v49, s64, v48
    v_fma_f32 v50, v48, s64, -v49
    v_exp_f32 v49, v49
    v_fmac_f32 v50, s65, v48
    v_mul_f32 v50, s66, v50
    v_fmac_f32 v49, v49, v50
    v_cvt_pk_bf16_f32 v49, v49, v49
    v_lshlrev_b32 v51, 16, v49
    v_mul_f32 v20, 0xbfb8aa3b, v51
    v_mul_f32 v21, 0.15915494, v51
    v_add_f32 v22, v51, v51
    s_waitcnt vmcnt(1)
    s_cmp_eq_u32 s89, 0
    s_cbranch_scc1 L_kp0
    s_setprio 1
L_kp0:
    v_lshlrev_b32 v48, 16, v16
    v_lshlrev_b32 v171, 16, v17
    v_lshlrev_b32 v172, 16, v18
    v_lshlrev_b32 v173, 16, v19
    v_mul_f32 v49, s64, v48
    v_fma_f32 v50, v48, s64, -v49
    v_exp_f32 v49, v49
    v_fmac_f32 v50, s65, v48
    v_mul_f32 v50, s66, v50
    v_fmac_f32 v49, v49, v50
    v_cvt_pk_bf16_f32 v49, v49, v49
    v_lshlrev_b32 v170, 16, v49
    v_pk_mul_f32 v[172:173], v[172:173], v[22:23] op_sel_hi:[1,0]
    v_pk_mul_f32 v[170:171], v[170:171], v[20:21]
    v_cvt_pk_bf16_f32 v52, v172, -v173
    ds_write_addtid_b32 v52 offset:0
    v_pk_mul_f32 v[44:45], v[170:171], s[70:71] op_sel_hi:[1,0]
    v_fract_f32 v47, v45
    v_exp_f32 v46, v44
    v_cos_f32 v36, v47
    v_sin_f32 v37, v47
    s_nop 0
    v_pk_mul_f32 v[36:37], v[36:37], v[46:47] op_sel_hi:[1,0]
    v_pk_mul_f32 v[44:45], v[170:171], s[68:69] op_sel_hi:[1,0]
    v_fract_f32 v47, v45
    v_exp_f32 v46, v44
    v_cos_f32 v34, v47
    v_sin_f32 v35, v47
    s_nop 0
    v_pk_mul_f32 v[34:35], v[34:35], v[46:47] op_sel_hi:[1,0]
    v_fract_f32 v47, v171
    v_exp_f32 v46, v170
    v_cos_f32 v32, v47
    v_sin_f32 v33, v47
    s_nop 0
    v_pk_mul_f32 v[32:33], v[32:33], v[46:47] op_sel_hi:[1,0]
    v_pk_mul_f32 v[42:43], v[172:173], v[36:37] op_sel:[1,1] op_sel_hi:[1,0] neg_lo:[1,0]
    v_pk_fma_f32 v[40:41], v[172:173], v[36:37], v[42:43] op_sel_hi:[0,1,1]
    v_cvt_pk_bf16_f32 v53, v40, -v41
    ds_write_addtid_b32 v53 offset:16512
    v_pk_mul_f32 v[42:43], v[40:41], v[36:37] op_sel:[1,1] op_sel_hi:[1,0] neg_lo:[1,0]
    v_pk_fma_f32 v[40:41], v[40:41], v[36:37], v[42:43] op_sel_hi:[0,1,1]
    v_cvt_pk_bf16_f32 v54, v40, -v41
    ds_write_addtid_b32 v54 offset:24768
    v_pk_mul_f32 v[42:43], v[40:41], v[36:37] op_sel:[1,1] op_sel_hi:[1,0] neg_lo:[1,0]
    v_pk_fma_f32 v[40:41], v[40:41], v[36:37], v[42:43] op_sel_hi:[0,1,1]
    v_cvt_pk_bf16_f32 v55, v40, -v41
    ds_write_addtid_b32 v55 offset:33024
    v_pk_mul_f32 v[42:43], v[40:41], v[36:37] op_sel:[1,1] op_sel_hi:[1,0] neg_lo:[1,0]
    v_pk_fma_f32 v[40:41], v[40:41], v[36:37], v[42:43] op_sel_hi:[0,1,1]
    v_cvt_pk_bf16_f32 v52, v40, -v41
    ds_write_addtid_b32 v52 offset:41280
    v_pk_mul_f32 v[42:43], v[40:41], v[36:37] op_sel:[1,1] op_sel_hi:[1,0] neg_lo:[1,0]
    v_pk_fma_f32 v[40:41], v[40:41], v[36:37], v[42:43] op_sel_hi:[0,1,1]
    v_cvt_pk_bf16_f32 v53, v40, -v41
    ds_write_addtid_b32 v53 offset:37152
    v_pk_mul_f32 v[42:43], v[40:41], v[36:37] op_sel:[1,1] op_sel_hi:[1,0] neg_lo:[1,0]
    v_pk_fma_f32 v[40:41], v[40:41], v[36:37], v[42:43] op_sel_hi:[0,1,1]
    v_cvt_pk_bf16_f32 v54, v40, -v41
    ds_write_addtid_b32 v54 offset:45408
    v_pk_mul_f32 v[42:43], v[40:41], v[36:37] op_sel:[1,1] op_sel_hi:[1,0] neg_lo:[1,0]
    v_pk_fma_f32 v[40:41], v[40:41], v[36:37], v[42:43] op_sel_hi:[0,1,1]
    v_cvt_pk_bf16_f32 v55, v40, -v41
    ds_write_addtid_b32 v55 offset:39216
    v_pk_mul_f32 v[42:43], v[40:41], v[36:37] op_sel:[1,1] op_sel_hi:[1,0] neg_lo:[1,0]
    v_pk_fma_f32 v[40:41], v[40:41], v[36:37], v[42:43] op_sel_hi:[0,1,1]
    v_cvt_pk_bf16_f32 v52, v40, -v41
    ds_write_addtid_b32 v52 offset:47472
    v_pk_mul_f32 v[42:43], v[172:173], v[32:33] op_sel:[1,1] op_sel_hi:[1,0] neg_lo:[1,0]
    v_pk_fma_f32 v[38:39], v[172:173], v[32:33], v[42:43] op_sel_hi:[0,1,1]
    v_cvt_pk_bf16_f32 v53, v38, -v39
    ds_write_addtid_b32 v53 offset:2064
    v_pk_mul_f32 v[42:43], v[38:39], v[32:33] op_sel:[1,1] op_sel_hi:[1,0] neg_lo:[1,0]
    v_pk_fma_f32 v[38:39], v[38:39], v[32:33], v[42:43] op_sel_hi:[0,1,1]
    v_cvt_pk_bf16_f32 v54, v38, -v39
    ds_write_addtid_b32 v54 offset:4128
    v_pk_mul_f32 v[42:43], v[38:39], v[36:37] op_sel:[1,1] op_sel_hi:[1,0] neg_lo:[1,0]
    v_pk_fma_f32 v[40:41], v[38:39], v[36:37], v[42:43] op_sel_hi:[0,1,1]
    v_cvt_pk_bf16_f32 v55, v40, -v41
    ds_write_addtid_b32 v55 offset:18576
    v_pk_mul_f32 v[42:43], v[38:39], v[32:33] op_sel:[1,1] op_sel_hi:[1,0] neg_lo:[1,0]
    v_pk_fma_f32 v[38:39], v[38:39], v[32:33], v[42:43] op_sel_hi:[0,1,1]
    v_cvt_pk_bf16_f32 v52, v38, -v39
    ds_write_addtid_b32 v52 offset:6192
    v_pk_mul_f32 v[42:43], v[38:39], v[32:33] op_sel:[1,1] op_sel_hi:[1,0] neg_lo:[1,0]
    v_pk_fma_f32 v[38:39], v[38:39], v[32:33], v[42:43] op_sel_hi:[0,1,1]
    v_cvt_pk_bf16_f32 v53, v38, -v39
    ds_write_addtid_b32 v53 offset:8256
    v_pk_mul_f32 v[42:43], v[38:39], v[36:37] op_sel:[1,1] op_sel_hi:[1,0] neg_lo:[1,0]
    v_pk_fma_f32 v[40:41], v[38:39], v[36:37], v[42:43] op_sel_hi:[0,1,1]
    v_cvt_pk_bf16_f32 v54, v40, -v41
    ds_write_addtid_b32 v54 offset:20640
    v_pk_mul_f32 v[42:43], v[40:41], v[36:37] op_sel:[1,1] op_sel_hi:[1,0] neg_lo:[1,0]
    v_pk_fma_f32 v[40:41], v[40:41], v[36:37], v[42:43] op_sel_hi:[0,1,1]
    v_cvt_pk_bf16_f32 v55, v40, -v41
    ds_write_addtid_b32 v55 offset:26832
    v_pk_mul_f32 v[42:43], v[40:41], v[36:37] op_sel:[1,1] op_sel_hi:[1,0] neg_lo:[1,0]
    v_pk_fma_f32 v[40:41], v[40:41], v[36:37], v[42:43] op_sel_hi:[0,1,1]
    v_cvt_pk_bf16_f32 v52, v40, -v41
    ds_write_addtid_b32 v52 offset:35088
    s_mov_b64 exec, 7
    buffer_load_dwordx2 v[60:61], v7, s[48:51], 0 offen
    s_mov_b64 exec, -1
    buffer_load_dwordx2 v[8:9], v24, s[48:51], s76 offen
    v_pk_mul_f32 v[42:43], v[38:39], v[32:33] op_sel:[1,1] op_sel_hi:[1,0] neg_lo:[1,0]
    v_pk_fma_f32 v[38:39], v[38:39], v[32:33], v[42:43] op_sel_hi:[0,1,1]
    v_cvt_pk_bf16_f32 v53, v38, -v39
    ds_write_addtid_b32 v53 offset:10320
    v_pk_mul_f32 v[42:43], v[38:39], v[32:33] op_sel:[1,1] op_sel_hi:[1,0] neg_lo:[1,0]
    v_pk_fma_f32 v[38:39], v[38:39], v[32:33], v[42:43] op_sel_hi:[0,1,1]
    v_cvt_pk_bf16_f32 v54, v38, -v39
    ds_write_addtid_b32 v54 offset:12384
    v_pk_mul_f32 v[42:43], v[38:39], v[36:37] op_sel:[1,1] op_sel_hi:[1,0] neg_lo:[1,0]
    v_pk_fma_f32 v[40:41], v[38:39], v[36:37], v[42:43] op_sel_hi:[0,1,1]
    v_cvt_pk_bf16_f32 v55, v40, -v41
    ds_write_addtid_b32 v55 offset:22704
    v_pk_mul_f32 v[42:43], v[38:39], v[32:33] op_sel:[1,1] op_sel_hi:[1,0] neg_lo:[1,0]
    v_pk_fma_f32 v[38:39], v[38:39], v[32:33], v[42:43] op_sel_hi:[0,1,1]
    v_cvt_pk_bf16_f32 v52, v38, -v39
    ds_write_addtid_b32 v52 offset:14448
    v_cvt_pk_bf16_f32 v53, v34, v35
    ds_read_b128 v[80:83], v166 offset:0
    ds_write_addtid_b32 v53 offset:63984
    v_pk_mul_f32 v[42:43], v[34:35], v[34:35] op_sel:[1,1] op_sel_hi:[1,0] neg_lo:[1,0]
    v_pk_fma_f32 v[38:39], v[34:35], v[34:35], v[42:43] op_sel_hi:[0,1,1]
    ds_read_b128 v[84:87], v166 offset:32
    v_cvt_pk_bf16_f32 v54, v38, v39
    ds_write_addtid_b32 v54 offset:61920
    v_pk_mul_f32 v[42:43], v[38:39], v[34:35] op_sel:[1,1] op_sel_hi:[1,0] neg_lo:[1,0]
    ds_read_b128 v[88:91], v166 offset:64
    v_pk_fma_f32 v[38:39], v[38:39], v[34:35], v[42:43] op_sel_hi:[0,1,1]
    v_cvt_pk_bf16_f32 v55, v38, v39
    ds_write_addtid_b32 v55 offset:59856
    ds_read_b128 v[92:95], v166 offset:96
    v_pk_mul_f32 v[42:43], v[38:39], v[34:35] op_sel:[1,1] op_sel_hi:[1,0] neg_lo:[1,0]
    v_pk_fma_f32 v[38:39], v[38:39], v[34:35], v[42:43] op_sel_hi:[0,1,1]
    v_cvt_pk_bf16_f32 v52, v38, v39
    ds_read_b128 v[96:99], v166 offset:128
    ds_write_addtid_b32 v52 offset:57792
    v_pk_mul_f32 v[42:43], v[38:39], v[34:35] op_sel:[1,1] op_sel_hi:[1,0] neg_lo:[1,0]
    v_pk_fma_f32 v[38:39], v[38:39], v[34:35], v[42:43] op_sel_hi:[0,1,1]
    ds_read_b128 v[100:103], v166 offset:160
    v_cvt_pk_bf16_f32 v53, v38, v39
    ds_write_addtid_b32 v53 offset:55728
    v_pk_mul_f32 v[42:43], v[38:39], v[34:35] op_sel:[1,1] op_sel_hi:[1,0] neg_lo:[1,0]
    ds_read_b128 v[104:107], v166 offset:192
    v_pk_fma_f32 v[38:39], v[38:39], v[34:35], v[42:43] op_sel_hi:[0,1,1]
    v_cvt_pk_bf16_f32 v54, v38, v39
    ds_write_addtid_b32 v54 offset:53664
    ds_read_b128 v[108:111], v166 offset:224
    v_pk_mul_f32 v[42:43], v[38:39], v[34:35] op_sel:[1,1] op_sel_hi:[1,0] neg_lo:[1,0]
    v_pk_fma_f32 v[38:39], v[38:39], v[34:35], v[42:43] op_sel_hi:[0,1,1]
    v_cvt_pk_bf16_f32 v55, v38, v39
    ds_write_addtid_b32 v55 offset:51600
    v_pk_mul_f32 v[42:43], v[38:39], v[34:35] op_sel:[1,1] op_sel_hi:[1,0] neg_lo:[1,0]
    v_pk_fma_f32 v[38:39], v[38:39], v[34:35], v[42:43] op_sel_hi:[0,1,1]
    v_cvt_pk_bf16_f32 v52, v38, v39
    ds_write_addtid_b32 v52 offset:49536
    v_pk_mul_f32 v[42:43], v[38:39], v[34:35] op_sel:[1,1] op_sel_hi:[1,0] neg_lo:[1,0]
    v_pk_fma_f32 v[38:39], v[38:39], v[34:35], v[42:43] op_sel_hi:[0,1,1]
    v_cvt_pk_bf16_f32 v53, v38, v39
    ds_write_addtid_b32 v53 offset:47472
    v_pk_mul_f32 v[42:43], v[38:39], v[34:35] op_sel:[1,1] op_sel_hi:[1,0] neg_lo:[1,0]
    v_pk_fma_f32 v[38:39], v[38:39], v[34:35], v[42:43] op_sel_hi:[0,1,1]
    v_cvt_pk_bf16_f32 v54, v38, v39
    ds_write_addtid_b32 v54 offset:45408
    v_pk_mul_f32 v[42:43], v[38:39], v[34:35] op_sel:[1,1] op_sel_hi:[1,0] neg_lo:[1,0]
    v_pk_fma_f32 v[38:39], v[38:39], v[34:35], v[42:43] op_sel_hi:[0,1,1]
    v_cvt_pk_bf16_f32 v55, v38, v39
    ds_write_addtid_b32 v55 offset:43344
    v_pk_mul_f32 v[42:43], v[38:39], v[34:35] op_sel:[1,1] op_sel_hi:[1,0] neg_lo:[1,0]
    v_pk_fma_f32 v[38:39], v[38:39], v[34:35], v[42:43] op_sel_hi:[0,1,1]
    v_cvt_pk_bf16_f32 v52, v38, v39
    ds_write_addtid_b32 v52 offset:41280
    v_pk_mul_f32 v[42:43], v[38:39], v[34:35] op_sel:[1,1] op_sel_hi:[1,0] neg_lo:[1,0]
    v_pk_fma_f32 v[38:39], v[38:39], v[34:35], v[42:43] op_sel_hi:[0,1,1]
    v_cvt_pk_bf16_f32 v53, v38, v39
    ds_write_addtid_b32 v53 offset:39216
    v_pk_mul_f32 v[42:43], v[38:39], v[34:35] op_sel:[1,1] op_sel_hi:[1,0] neg_lo:[1,0]
    v_pk_fma_f32 v[38:39], v[38:39], v[34:35], v[42:43] op_sel_hi:[0,1,1]
    v_cvt_pk_bf16_f32 v54, v38, v39
    ds_write_addtid_b32 v54 offset:37152
    v_pk_mul_f32 v[42:43], v[38:39], v[34:35] op_sel:[1,1] op_sel_hi:[1,0] neg_lo:[1,0]
    v_pk_fma_f32 v[38:39], v[38:39], v[34:35], v[42:43] op_sel_hi:[0,1,1]
    v_cvt_pk_bf16_f32 v55, v38, v39
    buffer_load_dwordx2 v[10:11], v24, s[48:51], s77 offen
    ds_write_addtid_b32 v55 offset:35088
    v_pk_mul_f32 v[42:43], v[38:39], v[34:35] op_sel:[1,1] op_sel_hi:[1,0] neg_lo:[1,0]
    v_pk_fma_f32 v[38:39], v[38:39], v[34:35], v[42:43] op_sel_hi:[0,1,1]
    v_cvt_pk_bf16_f32 v52, v38, v39
    ds_write_addtid_b32 v52 offset:33024
    v_pk_mul_f32 v[42:43], v[38:39], v[34:35] op_sel:[1,1] op_sel_hi:[1,0] neg_lo:[1,0]
    v_pk_fma_f32 v[38:39], v[38:39], v[34:35], v[42:43] op_sel_hi:[0,1,1]
    v_cvt_pk_bf16_f32 v53, v38, v39
    ds_write_addtid_b32 v53 offset:30960
    v_pk_mul_f32 v[42:43], v[38:39], v[34:35] op_sel:[1,1] op_sel_hi:[1,0] neg_lo:[1,0]
    v_pk_fma_f32 v[38:39], v[38:39], v[34:35], v[42:43] op_sel_hi:[0,1,1]
    v_cvt_pk_bf16_f32 v54, v38, v39
    ds_write_addtid_b32 v54 offset:28896
    v_pk_mul_f32 v[42:43], v[38:39], v[34:35] op_sel:[1,1] op_sel_hi:[1,0] neg_lo:[1,0]
    v_pk_fma_f32 v[38:39], v[38:39], v[34:35], v[42:43] op_sel_hi:[0,1,1]
    v_cvt_pk_bf16_f32 v55, v38, v39
    ds_write_addtid_b32 v55 offset:26832
    v_pk_mul_f32 v[42:43], v[38:39], v[34:35] op_sel:[1,1] op_sel_hi:[1,0] neg_lo:[1,0]
    v_pk_fma_f32 v[38:39], v[38:39], v[34:35], v[42:43] op_sel_hi:[0,1,1]
    v_cvt_pk_bf16_f32 v52, v38, v39
    ds_write_addtid_b32 v52 offset:24768
    v_pk_mul_f32 v[42:43], v[38:39], v[34:35] op_sel:[1,1] op_sel_hi:[1,0] neg_lo:[1,0]
    v_pk_fma_f32 v[38:39], v[38:39], v[34:35], v[42:43] op_sel_hi:[0,1,1]
    v_cvt_pk_bf16_f32 v53, v38, v39
    ds_write_addtid_b32 v53 offset:22704
    v_pk_mul_f32 v[42:43], v[38:39], v[34:35] op_sel:[1,1] op_sel_hi:[1,0] neg_lo:[1,0]
    v_pk_fma_f32 v[38:39], v[38:39], v[34:35], v[42:43] op_sel_hi:[0,1,1]
    v_cvt_pk_bf16_f32 v54, v38, v39
    ds_write_addtid_b32 v54 offset:20640
    v_pk_mul_f32 v[42:43], v[38:39], v[34:35] op_sel:[1,1] op_sel_hi:[1,0] neg_lo:[1,0]
    v_pk_fma_f32 v[38:39], v[38:39], v[34:35], v[42:43] op_sel_hi:[0,1,1]
    v_cvt_pk_bf16_f32 v55, v38, v39
    ds_write_addtid_b32 v55 offset:18576
    v_pk_mul_f32 v[42:43], v[38:39], v[34:35] op_sel:[1,1] op_sel_hi:[1,0] neg_lo:[1,0]
    v_pk_fma_f32 v[38:39], v[38:39], v[34:35], v[42:43] op_sel_hi:[0,1,1]
    v_cvt_pk_bf16_f32 v52, v38, v39
    ds_write_addtid_b32 v52 offset:16512
    v_pk_mul_f32 v[42:43], v[38:39], v[34:35] op_sel:[1,1] op_sel_hi:[1,0] neg_lo:[1,0]
    v_pk_fma_f32 v[38:39], v[38:39], v[34:35], v[42:43] op_sel_hi:[0,1,1]
    v_cvt_pk_bf16_f32 v53, v38, v39
    ds_write_addtid_b32 v53 offset:14448
    v_pk_mul_f32 v[42:43], v[38:39], v[34:35] op_sel:[1,1] op_sel_hi:[1,0] neg_lo:[1,0]
    v_pk_fma_f32 v[38:39], v[38:39], v[34:35], v[42:43] op_sel_hi:[0,1,1]
    v_cvt_pk_bf16_f32 v54, v38, v39
    ds_write_addtid_b32 v54 offset:12384
    v_pk_mul_f32 v[42:43], v[38:39], v[34:35] op_sel:[1,1] op_sel_hi:[1,0] neg_lo:[1,0]
    v_pk_fma_f32 v[38:39], v[38:39], v[34:35], v[42:43] op_sel_hi:[0,1,1]
    v_cvt_pk_bf16_f32 v55, v38, v39
    ds_write_addtid_b32 v55 offset:10320
    v_pk_mul_f32 v[42:43], v[38:39], v[34:35] op_sel:[1,1] op_sel_hi:[1,0] neg_lo:[1,0]
    v_pk_fma_f32 v[38:39], v[38:39], v[34:35], v[42:43] op_sel_hi:[0,1,1]
    v_cvt_pk_bf16_f32 v52, v38, v39
    ds_write_addtid_b32 v52 offset:8256
    v_pk_mul_f32 v[42:43], v[38:39], v[34:35] op_sel:[1,1] op_sel_hi:[1,0] neg_lo:[1,0]
    v_pk_fma_f32 v[38:39], v[38:39], v[34:35], v[42:43] op_sel_hi:[0,1,1]
    v_cvt_pk_bf16_f32 v53, v38, v39
    ds_write_addtid_b32 v53 offset:6192
    v_pk_mul_f32 v[42:43], v[38:39], v[34:35] op_sel:[1,1] op_sel_hi:[1,0] neg_lo:[1,0]
    v_pk_fma_f32 v[38:39], v[38:39], v[34:35], v[42:43] op_sel_hi:[0,1,1]
    v_cvt_pk_bf16_f32 v54, v38, v39
    ds_write_addtid_b32 v54 offset:4128
    v_pk_mul_f32 v[42:43], v[38:39], v[34:35] op_sel:[1,1] op_sel_hi:[1,0] neg_lo:[1,0]
    v_pk_fma_f32 v[38:39], v[38:39], v[34:35], v[42:43] op_sel_hi:[0,1,1]
    v_cvt_pk_bf16_f32 v55, v38, v39
    ds_write_addtid_b32 v55 offset:2064
    ds_read_b128 v[112:115], v167 offset:0
    v_and_b32 v48, 0xffff0000, v16
    ds_read_b128 v[116:119], v167 offset:32
    v_and_b32 v171, 0xffff0000, v17
    ds_read_b128 v[120:123], v167 offset:64
    v_and_b32 v172, 0xffff0000, v18
    ds_read_b128 v[124:127], v167 offset:96
    v_and_b32 v173, 0xffff0000, v19
    ds_read_b128 v[128:131], v167 offset:128
    v_mul_f32 v49, s64, v48
    ds_read_b128 v[132:135], v167 offset:160
    v_fma_f32 v50, v48, s64, -v49
    ds_read_b128 v[136:139], v167 offset:192
    v_exp_f32 v49, v49
    ds_read_b128 v[140:143], v167 offset:224
    v_fmac_f32 v50, s65, v48
    buffer_load_dwordx2 v[12:13], v24, s[48:51], s78 offen
    v_mul_f32 v50, s66, v50
    v_fmac_f32 v49, v49, v50
    v_cvt_pk_bf16_f32 v49, v49, v49
    v_lshlrev_b32 v170, 16, v49
    v_mul_f32 v172, v22, v172
    v_mul_f32 v173, v22, v173
    v_mul_f32 v170, v20, v170
    v_mul_f32 v171, v21, v171
    v_cvt_pk_bf16_f32 v52, v172, -v173
    ds_write_addtid_b32 v52 offset:0
    v_mul_f32 v44, s70, v170
    v_mul_f32 v45, s70, v171
    v_fract_f32 v47, v45
    v_exp_f32 v46, v44
    v_cos_f32 v36, v47
    v_sin_f32 v37, v47
    s_waitcnt lgkmcnt(8)
    v_mfma_f32_32x32x16_bf16 v[64:79], v[80:83], v[112:115], 0
    v_mul_f32 v36, v36, v46
    v_mul_f32 v37, v37, v46
    v_sub_f32 v154, 0, v37
    v_mul_f32 v44, s68, v170
    v_mul_f32 v45, s68, v171
    s_waitcnt lgkmcnt(7)
    v_mfma_f32_32x32x16_bf16 v[64:79], v[84:87], v[116:119], v[64:79]
    v_fract_f32 v47, v45
    v_exp_f32 v46, v44
    v_cos_f32 v34, v47
    v_sin_f32 v35, v47
    v_mul_f32 v34, v34, v46
    s_waitcnt lgkmcnt(6)
    v_mfma_f32_32x32x16_bf16 v[64:79], v[88:91], v[120:123], v[64:79]
    v_mul_f32 v35, v35, v46
    v_sub_f32 v153, 0, v35
    v_fract_f32 v47, v171
    v_exp_f32 v46, v170
    v_cos_f32 v32, v47
    s_waitcnt lgkmcnt(5)
    v_mfma_f32_32x32x16_bf16 v[64:79], v[92:95], v[124:127], v[64:79]
    v_sin_f32 v33, v47
    v_mul_f32 v32, v32, v46
    v_mul_f32 v33, v33, v46
    v_sub_f32 v152, 0, v33
    v_mul_f32 v40, v173, v154
    s_waitcnt lgkmcnt(4)
    v_mfma_f32_32x32x16_bf16 v[64:79], v[96:99], v[128:131], v[64:79]
    v_mul_f32 v41, v173, v36
    v_fmac_f32 v40, v172, v36
    v_fmac_f32 v41, v172, v37
    v_cvt_pk_bf16_f32 v53, v40, -v41
    ds_write_addtid_b32 v53 offset:16512
    s_waitcnt lgkmcnt(4)
    v_mfma_f32_32x32x16_bf16 v[64:79], v[100:103], v[132:135], v[64:79]
    v_mul_f32 v158, v41, v154
    v_mul_f32 v159, v41, v36
    v_fmac_f32 v158, v40, v36
    v_fmac_f32 v159, v40, v37
    v_cvt_pk_bf16_f32 v54, v158, -v159
    s_waitcnt lgkmcnt(3)
    v_mfma_f32_32x32x16_bf16 v[64:79], v[104:107], v[136:139], v[64:79]
    ds_write_addtid_b32 v54 offset:24768
    v_mul_f32 v40, v159, v154
    s_setprio 0
    v_mul_f32 v41, v159, v36
    v_fmac_f32 v40, v158, v36
    v_fmac_f32 v41, v158, v37
    s_waitcnt lgkmcnt(3)
    v_mfma_f32_32x32x16_bf16 v[64:79], v[108:111], v[140:143], v[64:79]
    v_cvt_pk_bf16_f32 v55, v40, -v41
    ds_write_addtid_b32 v55 offset:33024
    v_pk_mul_f32 v[42:43], v[40:41], v[36:37] op_sel:[1,1] op_sel_hi:[1,0] neg_lo:[1,0]
    v_pk_fma_f32 v[158:159], v[40:41], v[36:37], v[42:43] op_sel_hi:[0,1,1]
    v_cvt_pk_bf16_f32 v52, v158, -v159
    ds_write_addtid_b32 v52 offset:41280
    v_pk_mul_f32 v[42:43], v[158:159], v[36:37] op_sel:[1,1] op_sel_hi:[1,0] neg_lo:[1,0]
    v_pk_fma_f32 v[40:41], v[158:159], v[36:37], v[42:43] op_sel_hi:[0,1,1]
    v_cvt_pk_bf16_f32 v53, v40, -v41
    ds_write_addtid_b32 v53 offset:37152
    v_pk_mul_f32 v[42:43], v[40:41], v[36:37] op_sel:[1,1] op_sel_hi:[1,0] neg_lo:[1,0]
    v_pk_fma_f32 v[158:159], v[40:41], v[36:37], v[42:43] op_sel_hi:[0,1,1]
    v_cvt_pk_bf16_f32 v54, v158, -v159
    ds_write_addtid_b32 v54 offset:45408
    v_pk_mul_f32 v[42:43], v[158:159], v[36:37] op_sel:[1,1] op_sel_hi:[1,0] neg_lo:[1,0]
    v_pk_fma_f32 v[40:41], v[158:159], v[36:37], v[42:43] op_sel_hi:[0,1,1]
    v_cvt_pk_bf16_f32 v55, v40, -v41
    ds_write_addtid_b32 v55 offset:39216
    v_pk_mul_f32 v[42:43], v[40:41], v[36:37] op_sel:[1,1] op_sel_hi:[1,0] neg_lo:[1,0]
    v_pk_fma_f32 v[158:159], v[40:41], v[36:37], v[42:43] op_sel_hi:[0,1,1]
    v_cvt_pk_bf16_f32 v52, v158, -v159
    buffer_load_dwordx2 v[14:15], v24, s[48:51], s79 offen
    ds_write_addtid_b32 v52 offset:47472
    v_pk_mul_f32 v[42:43], v[172:173], v[32:33] op_sel:[1,1] op_sel_hi:[1,0] neg_lo:[1,0]
    v_pk_fma_f32 v[38:39], v[172:173], v[32:33], v[42:43] op_sel_hi:[0,1,1]
    v_cvt_pk_bf16_f32 v53, v38, -v39
    ds_write_addtid_b32 v53 offset:2064
    v_pk_mul_f32 v[42:43], v[38:39], v[32:33] op_sel:[1,1] op_sel_hi:[1,0] neg_lo:[1,0]
    v_pk_fma_f32 v[156:157], v[38:39], v[32:33], v[42:43] op_sel_hi:[0,1,1]
    v_cvt_pk_bf16_f32 v54, v156, -v157
    ds_write_addtid_b32 v54 offset:4128
    v_pk_mul_f32 v[42:43], v[156:157], v[36:37] op_sel:[1,1] op_sel_hi:[1,0] neg_lo:[1,0]
    v_pk_fma_f32 v[40:41], v[156:157], v[36:37], v[42:43] op_sel_hi:[0,1,1]
    v_cvt_pk_bf16_f32 v55, v40, -v41
    ds_write_addtid_b32 v55 offset:18576
    v_pk_mul_f32 v[42:43], v[156:157], v[32:33] op_sel:[1,1] op_sel_hi:[1,0] neg_lo:[1,0]
    v_pk_fma_f32 v[38:39], v[156:157], v[32:33], v[42:43] op_sel_hi:[0,1,1]
    v_cvt_pk_bf16_f32 v52, v38, -v39
    ds_write_addtid_b32 v52 offset:6192
    v_pk_mul_f32 v[42:43], v[38:39], v[32:33] op_sel:[1,1] op_sel_hi:[1,0] neg_lo:[1,0]
    v_pk_fma_f32 v[156:157], v[38:39], v[32:33], v[42:43] op_sel_hi:[0,1,1]
    v_cvt_pk_bf16_f32 v53, v156, -v157
    ds_write_addtid_b32 v53 offset:8256
    v_pk_mul_f32 v[42:43], v[156:157], v[36:37] op_sel:[1,1] op_sel_hi:[1,0] neg_lo:[1,0]
    v_pk_fma_f32 v[40:41], v[156:157], v[36:37], v[42:43] op_sel_hi:[0,1,1]
    v_cvt_pk_bf16_f32 v54, v40, -v41
    ds_write_addtid_b32 v54 offset:20640
    v_pk_mul_f32 v[42:43], v[40:41], v[36:37] op_sel:[1,1] op_sel_hi:[1,0] neg_lo:[1,0]
    v_pk_fma_f32 v[158:159], v[40:41], v[36:37], v[42:43] op_sel_hi:[0,1,1]
    v_cvt_pk_bf16_f32 v55, v158, -v159
    ds_write_addtid_b32 v55 offset:26832
    v_pk_mul_f32 v[42:43], v[158:159], v[36:37] op_sel:[1,1] op_sel_hi:[1,0] neg_lo:[1,0]
    v_pk_fma_f32 v[40:41], v[158:159], v[36:37], v[42:43] op_sel_hi:[0,1,1]
    v_cvt_pk_bf16_f32 v52, v40, -v41
    ds_write_addtid_b32 v52 offset:35088
    v_pk_mul_f32 v[42:43], v[156:157], v[32:33] op_sel:[1,1] op_sel_hi:[1,0] neg_lo:[1,0]
    v_pk_fma_f32 v[38:39], v[156:157], v[32:33], v[42:43] op_sel_hi:[0,1,1]
    v_cvt_pk_bf16_f32 v53, v38, -v39
    ds_write_addtid_b32 v53 offset:10320
    v_pk_mul_f32 v[42:43], v[38:39], v[32:33] op_sel:[1,1] op_sel_hi:[1,0] neg_lo:[1,0]
    v_pk_fma_f32 v[156:157], v[38:39], v[32:33], v[42:43] op_sel_hi:[0,1,1]
    v_cvt_pk_bf16_f32 v54, v156, -v157
    ds_write_addtid_b32 v54 offset:12384
    v_pk_mul_f32 v[42:43], v[156:157], v[36:37] op_sel:[1,1] op_sel_hi:[1,0] neg_lo:[1,0]
    v_pk_fma_f32 v[40:41], v[156:157], v[36:37], v[42:43] op_sel_hi:[0,1,1]
    v_cvt_pk_bf16_f32 v55, v40, -v41
    ds_write_addtid_b32 v55 offset:22704
    v_pk_mul_f32 v[42:43], v[156:157], v[32:33] op_sel:[1,1] op_sel_hi:[1,0] neg_lo:[1,0]
    v_pk_fma_f32 v[38:39], v[156:157], v[32:33], v[42:43] op_sel_hi:[0,1,1]
    v_cvt_pk_bf16_f32 v52, v38, -v39
    ds_write_addtid_b32 v52 offset:14448
    v_cvt_pk_bf16_f32 v53, v34, v35
    ds_read_b128 v[80:83], v166 offset:0
    ds_write_addtid_b32 v53 offset:63984
    v_pk_mul_f32 v[42:43], v[34:35], v[34:35] op_sel:[1,1] op_sel_hi:[1,0] neg_lo:[1,0]
    v_pk_fma_f32 v[38:39], v[34:35], v[34:35], v[42:43] op_sel_hi:[0,1,1]
    ds_read_b128 v[84:87], v166 offset:32
    v_cvt_pk_bf16_f32 v54, v38, v39
    ds_write_addtid_b32 v54 offset:61920
    v_pk_mul_f32 v[42:43], v[38:39], v[34:35] op_sel:[1,1] op_sel_hi:[1,0] neg_lo:[1,0]
    ds_read_b128 v[88:91], v166 offset:64
    v_pk_fma_f32 v[156:157], v[38:39], v[34:35], v[42:43] op_sel_hi:[0,1,1]
    v_cvt_pk_bf16_f32 v55, v156, v157
    ds_write_addtid_b32 v55 offset:59856
    ds_read_b128 v[92:95], v166 offset:96
    v_pk_mul_f32 v[42:43], v[156:157], v[34:35] op_sel:[1,1] op_sel_hi:[1,0] neg_lo:[1,0]
    v_pk_fma_f32 v[38:39], v[156:157], v[34:35], v[42:43] op_sel_hi:[0,1,1]
    v_cvt_pk_bf16_f32 v52, v38, v39
    ds_read_b128 v[96:99], v166 offset:128
    ds_write_addtid_b32 v52 offset:57792
    v_pk_mul_f32 v[42:43], v[38:39], v[34:35] op_sel:[1,1] op_sel_hi:[1,0] neg_lo:[1,0]
    v_pk_fma_f32 v[156:157], v[38:39], v[34:35], v[42:43] op_sel_hi:[0,1,1]
    ds_read_b128 v[100:103], v166 offset:160
    v_cvt_pk_bf16_f32 v53, v156, v157
    ds_write_addtid_b32 v53 offset:55728
    v_pk_mul_f32 v[42:43], v[156:157], v[34:35] op_sel:[1,1] op_sel_hi:[1,0] neg_lo:[1,0]
    ds_read_b128 v[104:107], v166 offset:192
    v_pk_fma_f32 v[38:39], v[156:157], v[34:35], v[42:43] op_sel_hi:[0,1,1]
    v_cvt_pk_bf16_f32 v54, v38, v39
    ds_write_addtid_b32 v54 offset:53664
    ds_read_b128 v[108:111], v166 offset:224
    v_pk_mul_f32 v[42:43], v[38:39], v[34:35] op_sel:[1,1] op_sel_hi:[1,0] neg_lo:[1,0]
    v_pk_fma_f32 v[156:157], v[38:39], v[34:35], v[42:43] op_sel_hi:[0,1,1]
    v_cvt_pk_bf16_f32 v55, v156, v157
    ds_write_addtid_b32 v55 offset:51600
    v_pk_mul_f32 v[42:43], v[156:157], v[34:35] op_sel:[1,1] op_sel_hi:[1,0] neg_lo:[1,0]
    v_pk_fma_f32 v[38:39], v[156:157], v[34:35], v[42:43] op_sel_hi:[0,1,1]
    v_cvt_pk_bf16_f32 v52, v38, v39
    ds_write_addtid_b32 v52 offset:49536
    v_pk_mul_f32 v[42:43], v[38:39], v[34:35] op_sel:[1,1] op_sel_hi:[1,0] neg_lo:[1,0]
    v_pk_fma_f32 v[156:157], v[38:39], v[34:35], v[42:43] op_sel_hi:[0,1,1]
    v_cvt_pk_bf16_f32 v53, v156, v157
    ds_write_addtid_b32 v53 offset:47472
    v_pk_mul_f32 v[42:43], v[156:157], v[34:35] op_sel:[1,1] op_sel_hi:[1,0] neg_lo:[1,0]
    v_pk_fma_f32 v[38:39], v[156:157], v[34:35], v[42:43] op_sel_hi:[0,1,1]
    v_cvt_pk_bf16_f32 v54, v38, v39
    ds_write_addtid_b32 v54 offset:45408
    v_pk_mul_f32 v[42:43], v[38:39], v[34:35] op_sel:[1,1] op_sel_hi:[1,0] neg_lo:[1,0]
    v_pk_fma_f32 v[156:157], v[38:39], v[34:35], v[42:43] op_sel_hi:[0,1,1]
    v_cvt_pk_bf16_f32 v55, v156, v157
    ds_write_addtid_b32 v55 offset:43344
    v_pk_mul_f32 v[42:43], v[156:157], v[34:35] op_sel:[1,1] op_sel_hi:[1,0] neg_lo:[1,0]
    v_pk_fma_f32 v[38:39], v[156:157], v[34:35], v[42:43] op_sel_hi:[0,1,1]
    v_cvt_pk_bf16_f32 v52, v38, v39
    ds_write_addtid_b32 v52 offset:41280
    v_pk_mul_f32 v[42:43], v[38:39], v[34:35] op_sel:[1,1] op_sel_hi:[1,0] neg_lo:[1,0]
    v_pk_fma_f32 v[156:157], v[38:39], v[34:35], v[42:43] op_sel_hi:[0,1,1]
    v_cvt_pk_bf16_f32 v53, v156, v157
    ds_write_addtid_b32 v53 offset:39216
    v_pk_mul_f32 v[42:43], v[156:157], v[34:35] op_sel:[1,1] op_sel_hi:[1,0] neg_lo:[1,0]
    v_pk_fma_f32 v[38:39], v[156:157], v[34:35], v[42:43] op_sel_hi:[0,1,1]
    v_cvt_pk_bf16_f32 v54, v38, v39
    ds_write_addtid_b32 v54 offset:37152
    v_pk_mul_f32 v[42:43], v[38:39], v[34:35] op_sel:[1,1] op_sel_hi:[1,0] neg_lo:[1,0]
    v_pk_fma_f32 v[156:157], v[38:39], v[34:35], v[42:43] op_sel_hi:[0,1,1]
    v_cvt_pk_bf16_f32 v55, v156, v157
    ds_write_addtid_b32 v55 offset:35088
    v_pk_mul_f32 v[42:43], v[156:157], v[34:35] op_sel:[1,1] op_sel_hi:[1,0] neg_lo:[1,0]
    v_pk_fma_f32 v[38:39], v[156:157], v[34:35], v[42:43] op_sel_hi:[0,1,1]
    v_cvt_pk_bf16_f32 v52, v38, v39
    ds_write_addtid_b32 v52 offset:33024
    v_pk_mul_f32 v[42:43], v[38:39], v[34:35] op_sel:[1,1] op_sel_hi:[1,0] neg_lo:[1,0]
    v_pk_fma_f32 v[156:157], v[38:39], v[34:35], v[42:43] op_sel_hi:[0,1,1]
    v_cvt_pk_bf16_f32 v53, v156, v157
    ds_write_addtid_b32 v53 offset:30960
    v_pk_mul_f32 v[42:43], v[156:157], v[34:35] op_sel:[1,1] op_sel_hi:[1,0] neg_lo:[1,0]
    v_pk_fma_f32 v[38:39], v[156:157], v[34:35], v[42:43] op_sel_hi:[0,1,1]
    v_cvt_pk_bf16_f32 v54, v38, v39
    ds_write_addtid_b32 v54 offset:28896
    v_pk_mul_f32 v[42:43], v[38:39], v[34:35] op_sel:[1,1] op_sel_hi:[1,0] neg_lo:[1,0]
    v_pk_fma_f32 v[156:157], v[38:39], v[34:35], v[42:43] op_sel_hi:[0,1,1]
    v_cvt_pk_bf16_f32 v55, v156, v157
    global_load_dword v255, v168, s[22:23]
    ds_write_addtid_b32 v55 offset:26832
    v_pk_mul_f32 v[42:43], v[156:157], v[34:35] op_sel:[1,1] op_sel_hi:[1,0] neg_lo:[1,0]
    v_pk_fma_f32 v[38:39], v[156:157], v[34:35], v[42:43] op_sel_hi:[0,1,1]
    v_cvt_pk_bf16_f32 v52, v38, v39
    ds_write_addtid_b32 v52 offset:24768
    v_pk_mul_f32 v[42:43], v[38:39], v[34:35] op_sel:[1,1] op_sel_hi:[1,0] neg_lo:[1,0]
    v_pk_fma_f32 v[156:157], v[38:39], v[34:35], v[42:43] op_sel_hi:[0,1,1]
    v_cvt_pk_bf16_f32 v53, v156, v157
    ds_write_addtid_b32 v53 offset:22704
    v_pk_mul_f32 v[42:43], v[156:157], v[34:35] op_sel:[1,1] op_sel_hi:[1,0] neg_lo:[1,0]
    v_pk_fma_f32 v[38:39], v[156:157], v[34:35], v[42:43] op_sel_hi:[0,1,1]
    v_cvt_pk_bf16_f32 v54, v38, v39
    ds_write_addtid_b32 v54 offset:20640
    v_pk_mul_f32 v[42:43], v[38:39], v[34:35] op_sel:[1,1] op_sel_hi:[1,0] neg_lo:[1,0]
    v_pk_fma_f32 v[156:157], v[38:39], v[34:35], v[42:43] op_sel_hi:[0,1,1]
    v_cvt_pk_bf16_f32 v55, v156, v157
    ds_write_addtid_b32 v55 offset:18576
    v_pk_mul_f32 v[42:43], v[156:157], v[34:35] op_sel:[1,1] op_sel_hi:[1,0] neg_lo:[1,0]
    v_pk_fma_f32 v[38:39], v[156:157], v[34:35], v[42:43] op_sel_hi:[0,1,1]
    v_cvt_pk_bf16_f32 v52, v38, v39
    ds_write_addtid_b32 v52 offset:16512
    v_pk_mul_f32 v[42:43], v[38:39], v[34:35] op_sel:[1,1] op_sel_hi:[1,0] neg_lo:[1,0]
    v_pk_fma_f32 v[156:157], v[38:39], v[34:35], v[42:43] op_sel_hi:[0,1,1]
    v_cvt_pk_bf16_f32 v53, v156, v157
    ds_write_addtid_b32 v53 offset:14448
    v_pk_mul_f32 v[42:43], v[156:157], v[34:35] op_sel:[1,1] op_sel_hi:[1,0] neg_lo:[1,0]
    v_pk_fma_f32 v[38:39], v[156:157], v[34:35], v[42:43] op_sel_hi:[0,1,1]
    v_cvt_pk_bf16_f32 v54, v38, v39
    ds_write_addtid_b32 v54 offset:12384
    v_pk_mul_f32 v[42:43], v[38:39], v[34:35] op_sel:[1,1] op_sel_hi:[1,0] neg_lo:[1,0]
    v_pk_fma_f32 v[156:157], v[38:39], v[34:35], v[42:43] op_sel_hi:[0,1,1]
    v_cvt_pk_bf16_f32 v55, v156, v157
    ds_write_addtid_b32 v55 offset:10320
    v_pk_mul_f32 v[42:43], v[156:157], v[34:35] op_sel:[1,1] op_sel_hi:[1,0] neg_lo:[1,0]
    v_pk_fma_f32 v[38:39], v[156:157], v[34:35], v[42:43] op_sel_hi:[0,1,1]
    v_cvt_pk_bf16_f32 v52, v38, v39
    ds_write_addtid_b32 v52 offset:8256
    v_pk_mul_f32 v[42:43], v[38:39], v[34:35] op_sel:[1,1] op_sel_hi:[1,0] neg_lo:[1,0]
    v_pk_fma_f32 v[156:157], v[38:39], v[34:35], v[42:43] op_sel_hi:[0,1,1]
    v_cvt_pk_bf16_f32 v53, v156, v157
    ds_write_addtid_b32 v53 offset:6192
    v_pk_mul_f32 v[42:43], v[156:157], v[34:35] op_sel:[1,1] op_sel_hi:[1,0] neg_lo:[1,0]
    v_pk_fma_f32 v[38:39], v[156:157], v[34:35], v[42:43] op_sel_hi:[0,1,1]
    v_cvt_pk_bf16_f32 v54, v38, v39
    ds_write_addtid_b32 v54 offset:4128
    v_pk_mul_f32 v[42:43], v[38:39], v[34:35] op_sel:[1,1] op_sel_hi:[1,0] neg_lo:[1,0]
    v_pk_fma_f32 v[156:157], v[38:39], v[34:35], v[42:43] op_sel_hi:[0,1,1]
    v_cvt_pk_bf16_f32 v55, v156, v157
    ds_write_addtid_b32 v55 offset:2064
    ds_read_b128 v[112:115], v167 offset:0
    ds_read_b128 v[116:119], v167 offset:32
    ds_read_b128 v[120:123], v167 offset:64
    ds_read_b128 v[124:127], v167 offset:96
    ds_read_b128 v[128:131], v167 offset:128
    ds_read_b128 v[132:135], v167 offset:160
    ds_read_b128 v[136:139], v167 offset:192
    ds_read_b128 v[140:143], v167 offset:224
    s_cmp_eq_u32 s89, 0
    s_cbranch_scc1 L_A_lo
    s_waitcnt lgkmcnt(7)
    v_mfma_f32_32x32x16_bf16 v[64:79], v[80:83], v[112:115], v[64:79]
    s_waitcnt lgkmcnt(6)
    v_mfma_f32_32x32x16_bf16 v[64:79], v[84:87], v[116:119], v[64:79]
    s_waitcnt lgkmcnt(5)
    v_mfma_f32_32x32x16_bf16 v[64:79], v[88:91], v[120:123], v[64:79]
    s_waitcnt lgkmcnt(4)
    v_mfma_f32_32x32x16_bf16 v[64:79], v[92:95], v[124:127], v[64:79]
    s_waitcnt lgkmcnt(3)
    v_mfma_f32_32x32x16_bf16 v[64:79], v[96:99], v[128:131], v[64:79]
    s_waitcnt lgkmcnt(2)
    v_mfma_f32_32x32x16_bf16 v[64:79], v[100:103], v[132:135], v[64:79]
    s_waitcnt lgkmcnt(1)
    v_mfma_f32_32x32x16_bf16 v[64:79], v[104:107], v[136:139], v[64:79]
    s_waitcnt lgkmcnt(0)
    v_mfma_f32_32x32x16_bf16 v[64:79], v[108:111], v[140:143], v[64:79]
    s_nop 11
    ds_write_b128 v177, v[64:67] offset:0
    ds_write_b128 v177, v[68:71] offset:1024
    ds_write_b128 v177, v[72:75] offset:2048
    s_waitcnt lgkmcnt(0)
    s_barrier
    s_setprio 1
    s_waitcnt vmcnt(4)
    s_mov_b64 exec, 7
    ds_write_b64 v4, v[60:61]
    s_mov_b64 exec, -1
    ds_write_b64 v4, v[8:9] offset:24
    s_waitcnt vmcnt(3)
    ds_write_b64 v4, v[10:11] offset:536
    s_waitcnt vmcnt(2)
    ds_write_b64 v4, v[12:13] offset:1048
    s_waitcnt vmcnt(1)
    ds_write_b64 v4, v[14:15] offset:1560
    ds_read_b64_tr_b16 v[180:181], v5 offset:24
    ds_read_b64_tr_b16 v[182:183], v5 offset:16
    ds_read_b64_tr_b16 v[184:185], v5 offset:8
    ds_read_b64_tr_b16 v[186:187], v5 offset:0
    ds_read_b64_tr_b16 v[188:189], v5 offset:536
    ds_read_b64_tr_b16 v[190:191], v5 offset:528
    ds_read_b64_tr_b16 v[192:193], v5 offset:520
    s_waitcnt lgkmcnt(6)
    ds_write_b64 v6, v[180:181] offset:0
    ds_read_b64_tr_b16 v[194:195], v5 offset:512
    s_waitcnt lgkmcnt(7)
    ds_write_b64 v6, v[182:183] offset:4160
    ds_read_b64_tr_b16 v[180:181], v5 offset:1048
    s_waitcnt lgkmcnt(8)
    ds_write_b64 v6, v[184:185] offset:8320
    ds_read_b64_tr_b16 v[182:183], v5 offset:1040
    s_waitcnt lgkmcnt(9)
    ds_write_b64 v6, v[186:187] offset:12480
    ds_read_b64_tr_b16 v[184:185], v5 offset:1032
    s_waitcnt lgkmcnt(10)
    ds_write_b64 v6, v[188:189] offset:128
    ds_read_b64_tr_b16 v[186:187], v5 offset:1024
    s_waitcnt lgkmcnt(11)
    ds_write_b64 v6, v[190:191] offset:4288
    ds_read_b64_tr_b16 v[188:189], v5 offset:1560
    s_waitcnt lgkmcnt(12)
    ds_write_b64 v6, v[192:193] offset:8448
    ds_read_b64_tr_b16 v[190:191], v5 offset:1552
    s_waitcnt lgkmcnt(12)
    ds_write_b64 v6, v[194:195] offset:12608
    ds_read_b64_tr_b16 v[192:193], v5 offset:1544
    s_waitcnt lgkmcnt(12)
    ds_write_b64 v6, v[180:181] offset:256
    ds_read_b64_tr_b16 v[194:195], v5 offset:1536
    s_waitcnt lgkmcnt(12)
    ds_write_b64 v6, v[182:183] offset:4416
    s_waitcnt lgkmcnt(11)
    ds_write_b64 v6, v[184:185] offset:8576
    s_waitcnt lgkmcnt(10)
    ds_write_b64 v6, v[186:187] offset:12736
    s_waitcnt lgkmcnt(9)
    ds_write_b64 v6, v[188:189] offset:384
    s_waitcnt lgkmcnt(8)
    ds_write_b64 v6, v[190:191] offset:4544
    s_waitcnt lgkmcnt(7)
    ds_write_b64 v6, v[192:193] offset:8704
    s_waitcnt lgkmcnt(6)
    ds_write_b64 v6, v[194:195] offset:12864
    s_lshl_b32 s3, s88, 2
    s_add_u32 s3, s3, 163744
    v_mov_b32 v2, s3
    v_mov_b32 v3, 1
    s_mov_b64 exec, 1
    ds_write_b32 v2, v3
    s_mov_b64 exec, -1
    s_branch L_HELP
L_A_lo:
    s_waitcnt vmcnt(4)
    s_mov_b64 exec, 7
    ds_write_b64 v4, v[60:61]
    s_mov_b64 exec, -1
    ds_write_b64 v4, v[8:9] offset:24
    s_waitcnt vmcnt(3)
    ds_write_b64 v4, v[10:11] offset:536
    s_waitcnt vmcnt(2)
    ds_write_b64 v4, v[12:13] offset:1048
    s_waitcnt vmcnt(1)
    ds_write_b64 v4, v[14:15] offset:1560
    s_waitcnt lgkmcnt(12)
    v_mfma_f32_32x32x16_bf16 v[64:79], v[80:83], v[112:115], v[64:79]
    ds_read_b64_tr_b16 v[180:181], v5 offset:24
    ds_read_b64_tr_b16 v[182:183], v5 offset:16
    ds_read_b64_tr_b16 v[184:185], v5 offset:8
    ds_read_b64_tr_b16 v[186:187], v5 offset:0
    s_waitcnt lgkmcnt(15)
    v_mfma_f32_32x32x16_bf16 v[64:79], v[84:87], v[116:119], v[64:79]
    ds_read_b64_tr_b16 v[188:189], v5 offset:536
    ds_read_b64_tr_b16 v[190:191], v5 offset:528
    ds_read_b64_tr_b16 v[192:193], v5 offset:520
    s_waitcnt lgkmcnt(6)
    ds_write_b64 v6, v[180:181] offset:0
    v_mfma_f32_32x32x16_bf16 v[64:79], v[88:91], v[120:123], v[64:79]
    ds_read_b64_tr_b16 v[194:195], v5 offset:512
    s_waitcnt lgkmcnt(7)
    ds_write_b64 v6, v[182:183] offset:4160
    ds_read_b64_tr_b16 v[180:181], v5 offset:1048
    s_waitcnt lgkmcnt(8)
    ds_write_b64 v6, v[184:185] offset:8320
    v_mfma_f32_32x32x16_bf16 v[64:79], v[92:95], v[124:127], v[64:79]
    ds_read_b64_tr_b16 v[182:183], v5 offset:1040
    s_waitcnt lgkmcnt(9)
    ds_write_b64 v6, v[186:187] offset:12480
    ds_read_b64_tr_b16 v[184:185], v5 offset:1032
    s_waitcnt lgkmcnt(10)
    ds_write_b64 v6, v[188:189] offset:128
    v_mfma_f32_32x32x16_bf16 v[64:79], v[96:99], v[128:131], v[64:79]
    ds_read_b64_tr_b16 v[186:187], v5 offset:1024
    s_waitcnt lgkmcnt(11)
    ds_write_b64 v6, v[190:191] offset:4288
    ds_read_b64_tr_b16 v[188:189], v5 offset:1560
    s_waitcnt lgkmcnt(12)
    ds_write_b64 v6, v[192:193] offset:8448
    v_mfma_f32_32x32x16_bf16 v[64:79], v[100:103], v[132:135], v[64:79]
    ds_read_b64_tr_b16 v[190:191], v5 offset:1552
    s_waitcnt lgkmcnt(12)
    ds_write_b64 v6, v[194:195] offset:12608
    ds_read_b64_tr_b16 v[192:193], v5 offset:1544
    s_waitcnt lgkmcnt(12)
    ds_write_b64 v6, v[180:181] offset:256
    v_mfma_f32_32x32x16_bf16 v[64:79], v[104:107], v[136:139], v[64:79]
    ds_read_b64_tr_b16 v[194:195], v5 offset:1536
    s_waitcnt lgkmcnt(12)
    ds_write_b64 v6, v[182:183] offset:4416
    s_waitcnt lgkmcnt(11)
    ds_write_b64 v6, v[184:185] offset:8576
    s_waitcnt lgkmcnt(10)
    ds_write_b64 v6, v[186:187] offset:12736
    v_mfma_f32_32x32x16_bf16 v[64:79], v[108:111], v[140:143], v[64:79]
    s_waitcnt lgkmcnt(9)
    ds_write_b64 v6, v[188:189] offset:384
    s_waitcnt lgkmcnt(8)
    ds_write_b64 v6, v[190:191] offset:4544
    s_waitcnt lgkmcnt(7)
    ds_write_b64 v6, v[192:193] offset:8704
    s_waitcnt lgkmcnt(6)
    ds_write_b64 v6, v[194:195] offset:12864
    s_setprio 2
    s_waitcnt lgkmcnt(0)
    s_barrier
    ds_read_b128 v[80:83], v177 offset:0
    ds_read_b128 v[84:87], v177 offset:1024
    ds_read_b128 v[88:91], v177 offset:2048
    ds_read_b64 v[248:249], v25 offset:0
    ds_read_b64 v[250:251], v25 offset:8
    ds_read_b64 v[244:245], v25 offset:512
    ds_read_b64 v[246:247], v25 offset:520
    ds_read_b64 v[240:241], v25 offset:1024
    ds_read_b64 v[242:243], v25 offset:1032
    ds_read_b64 v[236:237], v25 offset:1536
    ds_read_b64 v[238:239], v25 offset:1544
    ds_read_b64 v[232:233], v25 offset:64
    ds_read_b64 v[234:235], v25 offset:72
    s_mul_i32 s42, s88, 4576
    s_add_u32 s42, s42, 4096
    v_min_u32 v3, 29, v1
    v_lshl_add_u32 v3, v3, 4, s42
    ds_write_b128 v3, v[56:59]
    v_add_f32 v64, v64, v176
    s_waitcnt lgkmcnt(13)
    v_pk_add_f32 v[64:65], v[64:65], v[80:81]
    v_pk_add_f32 v[66:67], v[66:67], v[82:83]
    s_waitcnt lgkmcnt(12)
    v_pk_add_f32 v[68:69], v[68:69], v[84:85]
    v_pk_add_f32 v[70:71], v[70:71], v[86:87]
    s_waitcnt lgkmcnt(11)
    v_pk_add_f32 v[72:73], v[72:73], v[88:89]
    v_pk_add_f32 v[74:75], v[74:75], v[90:91]
    v_cvt_pk_bf16_f32 v104, v67, v66
    v_cvt_pk_bf16_f32 v105, v65, v64
    ds_write_b64 v175, v[104:105]
    v_mov_b32_dpp v92, v72 wave_rol:1 row_mask:0xf bank_mask:0xf
    v_mov_b32_dpp v93, v74 wave_rol:1 row_mask:0xf bank_mask:0xf
    v_mov_b32_dpp v94, v75 wave_rol:1 row_mask:0xf bank_mask:0xf
    v_mov_b32_dpp v95, v75 wave_rol:1 row_mask:0xf bank_mask:0xf
    v_mov_b32_dpp v92, v68 wave_shl:1 row_mask:0xf bank_mask:0xf
    v_mov_b32_dpp v93, v72 wave_shl:1 row_mask:0xf bank_mask:0xf
    v_mov_b32_dpp v94, v74 wave_shl:1 row_mask:0xf bank_mask:0xf
    v_cndmask_b32 v96, v71, v92, s[72:73]
    v_cndmask_b32 v97, v70, v69, s[72:73]
    v_cndmask_b32 v98, v69, v68, s[72:73]
    v_cvt_pk_bf16_f32 v108, v92, v96
    v_cvt_pk_bf16_f32 v109, v97, v97
    v_cvt_pk_bf16_f32 v110, v97, v98
    v_cvt_pk_bf16_f32 v111, v68, v68
    ds_write_b128 v174, v[108:111] offset:2048
    v_cndmask_b32 v99, v73, v93, s[72:73]
    v_cndmask_b32 v100, v72, v93, s[74:75]
    v_cndmask_b32 v100, v73, v100, s[72:73]
    v_cndmask_b32 v101, v73, v72, s[72:73]
    v_cvt_pk_bf16_f32 v112, v93, v93
    v_cvt_pk_bf16_f32 v113, v99, v100
    v_cvt_pk_bf16_f32 v114, v101, v72
    v_cvt_pk_bf16_f32 v115, v72, v72
    ds_write_b128 v174, v[112:115] offset:1024
    v_cndmask_b32 v102, v74, v94, s[74:75]
    v_cvt_pk_bf16_f32 v116, v94, v94
    v_cvt_pk_bf16_f32 v117, v94, v102
    v_cvt_pk_bf16_f32 v118, v74, v74
    v_cvt_pk_bf16_f32 v119, v74, v74
    ds_write_b128 v174, v[116:119]
    v_cndmask_b32 v102, v75, v95, s[74:75]
    v_cvt_pk_bf16_f32 v120, v95, v95
    v_cvt_pk_bf16_f32 v121, v95, v102
    v_cvt_pk_bf16_f32 v122, v75, v75
    v_cvt_pk_bf16_f32 v123, v75, v75
    v_add_u32 v7, -1024, v174
    s_mov_b32 exec_hi, 0
    ds_write_b128 v7, v[120:123]
    s_mov_b32 exec_hi, -1
    s_branch L_CONV
L_B:
    s_lshl_b32 s3, s5, 7
    s_lshl_b32 s42, s7, 4
    s_add_u32 s3, s3, s42
    s_mul_i32 s3, s3, 896
    s_lshl_b32 s42, s4, 7
    s_add_u32 s3, s3, s42
    v_lshrrev_b32 v6, 3, v1
    v_mul_u32_u24 v6, 896, v6
    v_and_b32 v7, 7, v1
    v_lshl_add_u32 v6, v7, 4, v6
    v_add_u32 v52, s3, v6
    v_add_u32 v53, 7168, v52
    v_add_u32 v54, -7168, v52
    s_mul_i32 s93, s7, 3072
    s_lshl_b32 s91, s7, 11
    s_add_u32 s91, s91, 36992
    s_lshl_b32 s43, s4, 9
    v_lshl_add_u32 v5, v1, 3, s43
    s_waitcnt lgkmcnt(0)
    s_mov_b32 s52, s24
    s_mov_b32 s53, s25
    s_mov_b32 s54, 1835008
    s_mov_b32 s55, 0x20000
    s_mov_b32 s56, s26
    s_mov_b32 s57, s27
    s_mov_b32 s58, 1835008
    s_mov_b32 s59, 0x20000
    s_add_u32 m0, s93, 1024
    s_nop 0
    buffer_load_dwordx4 v52, s[52:55], 0 offen nt lds
    s_mov_b32 m0, s91
    s_nop 0
    buffer_load_dwordx4 v52, s[56:59], 0 offen nt lds
    s_add_u32 m0, s93, 2048
    s_nop 0
    buffer_load_dwordx4 v53, s[52:55], 0 offen nt lds
    s_add_u32 m0, s91, 1024
    s_nop 0
    buffer_load_dwordx4 v53, s[56:59], 0 offen nt lds
    s_mov_b32 m0, s93
    s_mov_b32 exec_lo, 0
    s_mov_b32 exec_hi, 0xffffff00
    buffer_load_dwordx4 v54, s[52:55], 0 offen nt lds
    s_mov_b64 exec, -1
    global_load_dwordx2 v[48:49], v5, s[28:29]
    v_bfe_u32 v2, v1, 2, 2
    v_lshlrev_b32 v2, 7, v2
    v_lshrrev_b32 v3, 4, v1
    v_lshl_add_u32 v2, v3, 5, v2
    v_and_b32 v3, 3, v1
    v_lshl_add_u32 v2, v3, 3, v2
    s_add_u32 s3, s93, 640
    v_add_u32 v55, s3, v2
    v_add_u32 v12, s91, v2
    s_lshr_b32 s42, s90, 1
    s_lshl_b32 s42, s42, 2
    s_load_dword s92, s[32:33], s42
    s_getreg_b32 s95, hwreg(HW_REG_XCC_ID, 0, 4)
    s_add_u32 s95, s95, 1
    s_lshl_b32 s3, s5, 4
    s_lshl_b32 s42, s7, 1
    s_add_u32 s3, s3, s42
    s_lshl_b32 s3, s3, 6
    s_lshl_b32 s42, s4, 18
    s_add_u32 s3, s3, s42
    v_lshrrev_b32 v6, 2, v1
    v_lshlrev_b32 v6, 14, v6
    v_lshl_add_u32 v6, v3, 4, v6
    v_add_u32 v13, s3, v6
    s_lshl_b32 s3, s6, 14
    v_lshl_add_u32 v14, v0, 4, s3
    s_lshl_b32 s42, s7, 11
    s_add_u32 s3, s3, s42
    v_and_b32 v2, 15, v1
    v_lshl_add_u32 v9, v2, 7, s3
    s_lshl_b32 s3, s4, 5
    v_mov_b32 v10, s3
    s_add_u32 s3, s3, s88
    v_lshl_add_u32 v60, v3, 2, s3
    v_mul_u32_u24 v6, 4576, v3
    v_bfe_u32 v7, v0, 2, 6
    v_lshlrev_b32 v7, 4, v7
    v_sub_u32 v6, v6, v7
    v_add_u32 v15, 1008, v6
    s_barrier
    global_load_dword v255, v10, s[36:37]
    s_lshl_b32 s3, s90, 12
    s_add_u32 s60, s30, s3
    s_addc_u32 s61, s31, 0
    s_mov_b32 s62, 4096
    s_mov_b32 s63, 0x20000
    s_lshl_b32 s3, s89, 11
    v_lshl_add_u32 v2, v1, 4, s3
    v_add_u32 v3, -8, v2
    buffer_load_dwordx4 v[66:69], v2, s[60:63], 0 offen nt
    buffer_load_dwordx4 v[72:75], v2, s[60:63], 0 offen offset:1024 nt
    s_mov_b32 exec_lo, 1
    s_mov_b32 exec_hi, 0
    buffer_load_dwordx2 v[64:65], v3, s[60:63], 0 offen nt
    s_mov_b64 exec, -1
    s_lshl_b32 s3, s6, 14
    s_lshl_b32 s42, s88, 12
    s_add_u32 s3, s3, s42
    v_and_b32 v11, 31, v1
    v_lshl_add_u32 v11, v11, 7, s3
    s_mov_b32 s48, s22
    s_mov_b32 s49, s23
    s_mov_b32 s50, 1835008
    s_mov_b32 s51, 0x20000
    s_mov_b32 s44, s34
    s_mov_b32 s45, s35
    s_mov_b32 s46, 3670016
    s_mov_b32 s47, 0x20000
    s_mov_b32 s72, s38
    s_mov_b32 s73, s39
    s_mov_b32 s74, 1835008
    s_mov_b32 s75, 0x20000
    s_mov_b32 s76, 4096
    s_mov_b32 s77, 8192
    s_mov_b32 s78, 12288
    v_mov_b32 v56, 0
    v_mov_b32 v57, 0
    v_mov_b32 v58, 0
    v_mov_b32 v59, 0
    v_lshlrev_b32 v4, 4, v1
    v_add_u32 v4, 163728, v4
    s_mov_b64 exec, 3
    ds_write_b128 v4, v[56:59]
    s_mov_b64 exec, -1
    v_bfe_u32 v9, v1, 3, 2
    v_mul_u32_u24 v9, 16672, v9
    v_bfe_u32 v10, v1, 1, 2
    v_mul_u32_u24 v10, 4160, v10
    v_add_u32 v9, v9, v10
    v_and_b32 v10, 1, v1
    v_lshl_add_u32 v9, v10, 4, v9
    v_add_u32 v9, 68112, v9
    ds_write_b128 v9, v[56:59]
    s_and_b32 s3, s90, 1
    s_lshl_b32 s3, s3, 4
    s_waitcnt lgkmcnt(0)
    s_lshr_b32 s92, s92, s3
    s_lshl_b32 s92, s92, 16
    s_waitcnt vmcnt(4)
    ds_read_b64_tr_b16 v[16:17], v55 offset:0
    ds_read_b64_tr_b16 v[22:23], v55 offset:128
    ds_read_b64_tr_b16 v[28:29], v12 offset:0
    ds_read_b64_tr_b16 v[18:19], v55 offset:512
    ds_read_b64_tr_b16 v[24:25], v55 offset:640
    ds_read_b64_tr_b16 v[30:31], v12 offset:512
    ds_read_b64_tr_b16 v[20:21], v55 offset:1024
    ds_read_b64_tr_b16 v[26:27], v55 offset:1152
    v_alignbit_b32 v50, v49, v49, 16
    v_alignbit_b32 v51, v48, v48, 16
    s_waitcnt lgkmcnt(5)
    v_dot2_f32_bf16 v100, v16, v50, 0
    v_dot2_f32_bf16 v101, v22, v50, 0
    v_lshlrev_b32 v116, 16, v28
    v_dot2_f32_bf16 v100, v17, v51, v100
    v_dot2_f32_bf16 v101, v23, v51, v101
    v_and_b32 v117, 0xffff0000, v28
    ds_read_b64_tr_b16 v[32:33], v55 offset:1024
    ds_read_b64_tr_b16 v[38:39], v55 offset:1152
    ds_read_b64_tr_b16 v[44:45], v12 offset:1024
    ds_read_b64_tr_b16 v[34:35], v55 offset:1536
    ds_read_b64_tr_b16 v[40:41], v55 offset:1664
    ds_read_b64_tr_b16 v[46:47], v12 offset:1536
    ds_read_b64_tr_b16 v[36:37], v55 offset:2048
    ds_read_b64_tr_b16 v[42:43], v55 offset:2176
    s_nop 1
    v_pk_mul_f32 v[100:101], v[100:101], v[116:117]
    v_cvt_pk_bf16_f32 v147, v101, v100
    s_waitcnt lgkmcnt(11)
    v_dot2_f32_bf16 v102, v17, v50, 0
    v_dot2_f32_bf16 v103, v23, v50, 0
    v_lshlrev_b32 v118, 16, v29
    v_dot2_f32_bf16 v102, v18, v51, v102
    v_dot2_f32_bf16 v103, v24, v51, v103
    v_and_b32 v119, 0xffff0000, v29
    s_nop 1
    v_pk_mul_f32 v[102:103], v[102:103], v[118:119]
    v_cvt_pk_bf16_f32 v146, v103, v102
    s_waitcnt lgkmcnt(10)
    v_dot2_f32_bf16 v104, v18, v50, 0
    v_dot2_f32_bf16 v105, v24, v50, 0
    v_lshlrev_b32 v120, 16, v30
    v_dot2_f32_bf16 v104, v19, v51, v104
    v_dot2_f32_bf16 v105, v25, v51, v105
    v_and_b32 v121, 0xffff0000, v30
    s_nop 1
    v_pk_mul_f32 v[104:105], v[104:105], v[120:121]
    v_cvt_pk_bf16_f32 v145, v105, v104
    s_waitcnt lgkmcnt(8)
    v_dot2_f32_bf16 v106, v19, v50, 0
    v_dot2_f32_bf16 v107, v25, v50, 0
    v_lshlrev_b32 v122, 16, v31
    v_dot2_f32_bf16 v106, v20, v51, v106
    v_dot2_f32_bf16 v107, v26, v51, v107
    v_and_b32 v123, 0xffff0000, v31
    s_nop 1
    v_pk_mul_f32 v[106:107], v[106:107], v[122:123]
    v_cvt_pk_bf16_f32 v144, v107, v106
    buffer_store_dwordx4 v[144:147], v13, s[72:75], 0 offen offset:0
    s_waitcnt lgkmcnt(5)
    v_dot2_f32_bf16 v108, v32, v50, 0
    v_dot2_f32_bf16 v109, v38, v50, 0
    v_lshlrev_b32 v124, 16, v44
    v_dot2_f32_bf16 v108, v33, v51, v108
    v_dot2_f32_bf16 v109, v39, v51, v109
    v_and_b32 v125, 0xffff0000, v44
    s_nop 1
    v_pk_mul_f32 v[108:109], v[108:109], v[124:125]
    v_cvt_pk_bf16_f32 v151, v109, v108
    s_waitcnt lgkmcnt(3)
    v_dot2_f32_bf16 v110, v33, v50, 0
    v_dot2_f32_bf16 v111, v39, v50, 0
    v_lshlrev_b32 v126, 16, v45
    v_dot2_f32_bf16 v110, v34, v51, v110
    v_dot2_f32_bf16 v111, v40, v51, v111
    v_and_b32 v127, 0xffff0000, v45
    s_nop 1
    v_pk_mul_f32 v[110:111], v[110:111], v[126:127]
    v_cvt_pk_bf16_f32 v150, v111, v110
    s_waitcnt lgkmcnt(2)
    v_dot2_f32_bf16 v112, v34, v50, 0
    v_dot2_f32_bf16 v113, v40, v50, 0
    v_lshlrev_b32 v128, 16, v46
    v_dot2_f32_bf16 v112, v35, v51, v112
    v_dot2_f32_bf16 v113, v41, v51, v113
    v_and_b32 v129, 0xffff0000, v46
    s_nop 1
    v_pk_mul_f32 v[112:113], v[112:113], v[128:129]
    v_cvt_pk_bf16_f32 v149, v113, v112
    s_waitcnt lgkmcnt(0)
    v_dot2_f32_bf16 v114, v35, v50, 0
    v_dot2_f32_bf16 v115, v41, v50, 0
    v_lshlrev_b32 v130, 16, v47
    v_dot2_f32_bf16 v114, v36, v51, v114
    v_dot2_f32_bf16 v115, v42, v51, v115
    v_and_b32 v131, 0xffff0000, v47
    s_nop 1
    v_pk_mul_f32 v[114:115], v[114:115], v[130:131]
    v_cvt_pk_bf16_f32 v148, v115, v114
    buffer_store_dwordx4 v[148:151], v13, s[72:75], 0 offen offset:64
    s_waitcnt vmcnt(2)
    s_cmp_eq_u32 s89, 0
    s_cbranch_scc1 L_B_i0
    global_load_dword v255, v11, s[38:39]
    v_mov_b32_dpp v64, v68 wave_shr:1 row_mask:0xf bank_mask:0xf
    v_mov_b32_dpp v70, v68 wave_ror:1 row_mask:0xf bank_mask:0xf
    v_mov_b32_dpp v65, v69 wave_shr:1 row_mask:0xf bank_mask:0xf
    v_mov_b32_dpp v71, v69 wave_ror:1 row_mask:0xf bank_mask:0xf
    v_mov_b32_dpp v70, v74 wave_shr:1 row_mask:0xf bank_mask:0xf
    s_nop 0
    v_mov_b32_dpp v71, v75 wave_shr:1 row_mask:0xf bank_mask:0xf
    s_cmp_eq_u32 s89, 0
    s_cselect_b32 s92, s92, 0
    v_cmp_eq_u32 vcc, 0, v1
    v_mov_b32 v2, s92
    s_nop 0
    v_cndmask_b32 v2, 0, v2, vcc
    v_lshlrev_b32 v3, 16, v66
    v_add_f32 v3, v3, v2
    v_cvt_pk_bf16_f32 v3, v3, v3
    s_mov_b32 s3, 0xffff
    v_bfi_b32 v66, s3, v3, v66
    s_mul_i32 s3, s88, 16672
    s_lshl_b32 s42, s89, 11
    s_add_u32 s3, s3, s42
    s_add_u32 s3, s3, 68144
    v_lshl_add_u32 v2, v1, 4, s3
    ds_write_b128 v2, v[66:69] offset:0
    v_alignbit_b32 v76, v66, v65, 16
    v_alignbit_b32 v77, v67, v66, 16
    v_alignbit_b32 v78, v68, v67, 16
    v_alignbit_b32 v79, v69, v68, 16
    ds_write_b128 v2, v[76:79] offset:4160
    v_mov_b32 v80, v65
    v_mov_b32 v81, v66
    v_mov_b32 v82, v67
    v_mov_b32 v83, v68
    ds_write_b128 v2, v[80:83] offset:8320
    v_alignbit_b32 v84, v65, v64, 16
    v_alignbit_b32 v85, v66, v65, 16
    v_alignbit_b32 v86, v67, v66, 16
    v_alignbit_b32 v87, v68, v67, 16
    ds_write_b128 v2, v[84:87] offset:12480
    ds_write_b128 v2, v[72:75] offset:1024
    v_alignbit_b32 v88, v72, v71, 16
    v_alignbit_b32 v89, v73, v72, 16
    v_alignbit_b32 v90, v74, v73, 16
    v_alignbit_b32 v91, v75, v74, 16
    ds_write_b128 v2, v[88:91] offset:5184
    v_mov_b32 v92, v71
    v_mov_b32 v93, v72
    v_mov_b32 v94, v73
    v_mov_b32 v95, v74
    ds_write_b128 v2, v[92:95] offset:9344
    v_alignbit_b32 v96, v71, v70, 16
    v_alignbit_b32 v97, v72, v71, 16
    v_alignbit_b32 v98, v73, v72, 16
    v_alignbit_b32 v99, v74, v73, 16
    ds_write_b128 v2, v[96:99] offset:13504
    s_waitcnt vmcnt(1)
    s_branch L_B_i1
L_B_i0:
    v_mov_b32_dpp v64, v68 wave_shr:1 row_mask:0xf bank_mask:0xf
    v_mov_b32_dpp v70, v68 wave_ror:1 row_mask:0xf bank_mask:0xf
    v_mov_b32_dpp v65, v69 wave_shr:1 row_mask:0xf bank_mask:0xf
    v_mov_b32_dpp v71, v69 wave_ror:1 row_mask:0xf bank_mask:0xf
    v_mov_b32_dpp v70, v74 wave_shr:1 row_mask:0xf bank_mask:0xf
    s_nop 0
    v_mov_b32_dpp v71, v75 wave_shr:1 row_mask:0xf bank_mask:0xf
    s_cmp_eq_u32 s89, 0
    s_cselect_b32 s92, s92, 0
    v_cmp_eq_u32 vcc, 0, v1
    v_mov_b32 v2, s92
    s_nop 0
    v_cndmask_b32 v2, 0, v2, vcc
    v_lshlrev_b32 v3, 16, v66
    v_add_f32 v3, v3, v2
    v_cvt_pk_bf16_f32 v3, v3, v3
    s_mov_b32 s3, 0xffff
    v_bfi_b32 v66, s3, v3, v66
    s_mul_i32 s3, s88, 16672
    s_lshl_b32 s42, s89, 11
    s_add_u32 s3, s3, s42
    s_add_u32 s3, s3, 68144
    v_lshl_add_u32 v2, v1, 4, s3
    ds_write_b128 v2, v[66:69] offset:0
    v_alignbit_b32 v76, v66, v65, 16
    v_alignbit_b32 v77, v67, v66, 16
    v_alignbit_b32 v78, v68, v67, 16
    v_alignbit_b32 v79, v69, v68, 16
    ds_write_b128 v2, v[76:79] offset:4160
    v_mov_b32 v80, v65
    v_mov_b32 v81, v66
    v_mov_b32 v82, v67
    v_mov_b32 v83, v68
    ds_write_b128 v2, v[80:83] offset:8320
    v_alignbit_b32 v84, v65, v64, 16
    v_alignbit_b32 v85, v66, v65, 16
    v_alignbit_b32 v86, v67, v66, 16
    v_alignbit_b32 v87, v68, v67, 16
    ds_write_b128 v2, v[84:87] offset:12480
    ds_write_b128 v2, v[72:75] offset:1024
    v_alignbit_b32 v88, v72, v71, 16
    v_alignbit_b32 v89, v73, v72, 16
    v_alignbit_b32 v90, v74, v73, 16
    v_alignbit_b32 v91, v75, v74, 16
    ds_write_b128 v2, v[88:91] offset:5184
    v_mov_b32 v92, v71
    v_mov_b32 v93, v72
    v_mov_b32 v94, v73
    v_mov_b32 v95, v74
    ds_write_b128 v2, v[92:95] offset:9344
    v_alignbit_b32 v96, v71, v70, 16
    v_alignbit_b32 v97, v72, v71, 16
    v_alignbit_b32 v98, v73, v72, 16
    v_alignbit_b32 v99, v74, v73, 16
    ds_write_b128 v2, v[96:99] offset:13504
    s_waitcnt vmcnt(0)
L_B_i1:
    s_barrier
    s_cmp_lg_u32 s7, 0
    s_cbranch_scc1 L_B_nf
    s_lshl_b32 s3, s4, 5
    s_add_u32 s3, s3, s5
    v_mov_b32 v2, s3
    v_mov_b32 v3, s95
    global_store_byte v2, v3, s[36:37]
L_B_nf:
    s_cmp_eq_u32 s89, 0
    s_cbranch_scc1 L_B_j2
    s_lshl_b32 s3, s88, 6
    v_add_u32 v2, s3, v1
    s_lshl_b32 s3, s6, 3
    v_mul_u32_u24 v6, 896, v2
    v_add_u32 v6, s3, v6
    s_mul_i32 s42, s94, 896
    s_add_u32 s3, s3, s42
    v_mul_u32_u24 v5, 1792, v2
    v_add_u32 v5, s3, v5
    s_mov_b32 s64, 0
    s_mov_b32 s8, 0
    s_mov_b32 s65, 229376
    s_mov_b32 s9, 458752
    s_mov_b32 s66, 458752
    s_mov_b32 s10, 917504
    s_mov_b32 s67, 688128
    s_mov_b32 s11, 1376256
    s_mov_b32 s68, 917504
    s_mov_b32 s12, 1835008
    s_mov_b32 s69, 1146880
    s_mov_b32 s13, 2293760
    s_mov_b32 s70, 1376256
    s_mov_b32 s14, 2752512
    s_mov_b32 s71, 1605632
    s_mov_b32 s15, 3211264
    v_and_b32 v2, 3, v1
    v_lshlrev_b32 v2, 2, v2
    v_add_u32 v2, 163744, v2
L_B_qw:
    ds_read_b32 v3, v2
    s_waitcnt lgkmcnt(0)
    v_cmp_eq_u32 vcc, 0, v3
    s_nop 1
    s_cbranch_vccz L_B_qg
    s_sleep 1
    s_branch L_B_qw
L_B_qg:
    buffer_load_dwordx2 v[168:169], v6, s[48:51], s64 offen
    buffer_load_dwordx2 v[170:171], v6, s[48:51], s65 offen
    buffer_load_dwordx2 v[172:173], v6, s[48:51], s66 offen
    buffer_load_dwordx2 v[174:175], v6, s[48:51], s67 offen
    v_mov_b32 v2, 0
    s_branch L_B_join
L_B_j2:
    global_load_ubyte v61, v60, s[36:37] sc1
    s_mul_i32 s42, s88, 4576
    s_add_u32 s42, s42, 4096
    v_min_u32 v2, 29, v1
    v_lshl_add_u32 v2, v2, 4, s42
    ds_write_b128 v2, v[56:59]
    v_and_b32 v2, 15, v1
    v_lshrrev_b32 v3, 4, v1
    v_sub_u32 v4, 15, v2
    v_and_b32 v5, 3, v4
    v_mul_u32_u24 v5, 4160, v5
    v_lshrrev_b32 v4, 2, v4
    v_lshlrev_b32 v4, 3, v4
    v_sub_u32 v5, v5, v4
    v_lshl_add_u32 v5, v3, 4, v5
    s_mul_i32 s3, s88, 16672
    s_add_u32 s3, s3, 68144
    v_add_u32 v25, s3, v5
    v_lshlrev_b32 v4, 5, v2
    v_lshlrev_b32 v5, 4, v3
    v_sub_u32 v5, v5, v4
    s_mul_i32 s3, s88, 4576
    s_add_u32 s3, s3, 480
    v_add_u32 v26, s3, v5
    v_mul_u32_u24 v5, 144, v3
    v_lshl_add_u32 v5, v2, 3, v5
    s_mul_i32 s3, s88, 4672
    s_add_u32 s3, s3, 18304
    v_add_u32 v27, s3, v5
    s_lshl_b32 s3, s88, 2
    s_add_u32 s3, s3, 163728
    v_mov_b32 v28, s3
    v_mov_b32 v29, 1
    v_and_b32 v2, 3, v1
    v_lshlrev_b32 v2, 2, v2
    v_add_u32 v30, 163744, v2
    s_xor_b32 s3, s94, 1
    v_mov_b32 v31, s3
    ds_read_b64 v[248:249], v25 offset:0
    ds_read_b64 v[250:251], v25 offset:8
    ds_read_b64 v[244:245], v25 offset:512
    ds_read_b64 v[246:247], v25 offset:520
    ds_read_b64 v[240:241], v25 offset:1024
    ds_read_b64 v[242:243], v25 offset:1032
    ds_read_b64 v[236:237], v25 offset:1536
    ds_read_b64 v[238:239], v25 offset:1544
    ds_read_b64 v[232:233], v25 offset:64
    ds_read_b64 v[234:235], v25 offset:72
    s_movk_i32 s93, 64
    s_branch L_B_p1
L_B_poll:
    global_load_ubyte v61, v60, s[36:37] sc1
L_B_p1:
    s_waitcnt vmcnt(0)
    v_cmp_ne_u32 vcc, s95, v61
    s_nop 1
    s_cbranch_vccz L_B_got
    s_sub_u32 s93, s93, 1
    s_cmp_lg_u32 s93, 0
    s_cbranch_scc1 L_B_poll
    s_lshl_b32 s3, s88, 2
    s_add_u32 s3, s3, 163744
    v_mov_b32 v2, s3
    v_mov_b32 v3, 1
    s_mov_b64 exec, 1
    ds_write_b32 v2, v3
    s_mov_b64 exec, -1
    v_mov_b32 v2, 1
    s_branch L_B_join
L_B_got:
    buffer_load_dwordx4 v[152:155], v14, s[72:75], 0 offen sc1
    buffer_load_dwordx4 v[156:159], v14, s[72:75], s76 offen sc1
    buffer_load_dwordx4 v[160:163], v14, s[72:75], s77 offen sc1
    buffer_load_dwordx4 v[164:167], v14, s[72:75], s78 offen sc1
    s_lshl_b32 s3, s88, 2
    s_add_u32 s3, s3, 163744
    v_mov_b32 v2, s3
    v_mov_b32 v3, 1
    s_mov_b64 exec, 1
    ds_write_b32 v2, v3
    s_mov_b64 exec, -1
    v_mov_b32 v2, 0
    s_waitcnt vmcnt(3)
    ds_write_b128 v15, v[152:155] offset:3072
    s_waitcnt vmcnt(2)
    ds_write_b128 v15, v[156:159] offset:2048
    s_waitcnt vmcnt(1)
    ds_write_b128 v15, v[160:163] offset:1024
    s_waitcnt vmcnt(0)
    ds_write_b128 v15, v[164:167] offset:0
L_B_join:
    s_lshl_b32 s3, s7, 8
    s_add_u32 s3, s3, 153296
    v_lshl_add_u32 v3, v1, 2, s3
    ds_write_b32 v3, v2
    v_and_b32 v3, 7, v1
    v_lshlrev_b32 v3, 8, v3
    v_add_u32 v3, 153296, v3
    s_waitcnt lgkmcnt(0)
    s_barrier
    ds_read_b32 v2, v3
    s_waitcnt lgkmcnt(0)
    v_cmp_ne_u32 vcc, 0, v2
    s_nop 1
    s_cbranch_vccnz L_B_fb
L_B_go:
    s_cmp_eq_u32 s89, 0
    s_cbranch_scc1 L_CONV
    buffer_load_dwordx2 v[176:177], v6, s[48:51], s68 offen
    buffer_load_dwordx2 v[178:179], v6, s[48:51], s69 offen
    buffer_load_dwordx2 v[180:181], v6, s[48:51], s70 offen
    buffer_load_dwordx2 v[182:183], v6, s[48:51], s71 offen
    s_branch L_HELP2
L_B_fb:
    s_lshl_b32 s3, s6, 5
    s_load_dwordx8 s[16:23], s[28:29], s3
    s_lshl_b32 s3, s6, 3
    v_mul_u32_u24 v24, 3584, v0
    v_add_u32 v40, s3, v24
    v_add_u32 v41, -2688, v40
    v_cmp_eq_u32 vcc, 0, v0
    v_bfrev_b32 v2, 1
    s_nop 0
    v_cndmask_b32 v41, v41, v2, vcc
    v_lshlrev_b32 v3, 3, v0
    v_sub_u32 v42, 4088, v3
    s_mov_b64 s[42:43], exec
    s_mov_b32 exec_lo, 1
    s_mov_b32 exec_hi, 0
    buffer_load_dwordx2 v[144:145], v41, s[52:55], 0 offen offset:0
    buffer_load_dwordx2 v[146:147], v41, s[52:55], 0 offen offset:896
    buffer_load_dwordx2 v[148:149], v41, s[52:55], 0 offen offset:1792
    s_mov_b64 exec, s[42:43]
    buffer_load_dwordx2 v[150:151], v40, s[52:55], 0 offen offset:0
    buffer_load_dwordx2 v[152:153], v40, s[52:55], 0 offen offset:896
    buffer_load_dwordx2 v[154:155], v40, s[52:55], 0 offen offset:1792
    buffer_load_dwordx2 v[156:157], v40, s[52:55], 0 offen offset:2688
    buffer_load_dwordx2 v[158:159], v40, s[56:59], 0 offen offset:0
    buffer_load_dwordx2 v[160:161], v40, s[56:59], 0 offen offset:896
    buffer_load_dwordx2 v[162:163], v40, s[56:59], 0 offen offset:1792
    buffer_load_dwordx2 v[164:165], v40, s[56:59], 0 offen offset:2688
    s_waitcnt lgkmcnt(0)
    s_lshl_b32 s72, s16, 16
    s_and_b32 s74, s16, 0xffff0000
    s_lshl_b32 s76, s17, 16
    s_and_b32 s78, s17, 0xffff0000
    s_lshl_b32 s73, s18, 16
    s_and_b32 s75, s18, 0xffff0000
    s_lshl_b32 s77, s19, 16
    s_and_b32 s79, s19, 0xffff0000
    s_lshl_b32 s80, s20, 16
    s_and_b32 s82, s20, 0xffff0000
    s_lshl_b32 s84, s21, 16
    s_and_b32 s86, s21, 0xffff0000
    s_lshl_b32 s81, s22, 16
    s_and_b32 s83, s22, 0xffff0000
    s_lshl_b32 s85, s23, 16
    s_and_b32 s87, s23, 0xffff0000
    s_waitcnt vmcnt(4)
    v_mov_b32_dpp v144, v152 wave_shr:1 row_mask:0xf bank_mask:0xf
    v_mov_b32_dpp v145, v153 wave_shr:1 row_mask:0xf bank_mask:0xf
    v_mov_b32_dpp v146, v154 wave_shr:1 row_mask:0xf bank_mask:0xf
    v_mov_b32_dpp v147, v155 wave_shr:1 row_mask:0xf bank_mask:0xf
    v_mov_b32_dpp v148, v156 wave_shr:1 row_mask:0xf bank_mask:0xf
    v_mov_b32_dpp v149, v157 wave_shr:1 row_mask:0xf bank_mask:0xf
    v_lshlrev_b32 v100, 16, v144
    v_and_b32 v101, 0xffff0000, v144
    v_lshlrev_b32 v102, 16, v146
    v_and_b32 v103, 0xffff0000, v146
    v_lshlrev_b32 v104, 16, v148
    v_and_b32 v105, 0xffff0000, v148
    v_lshlrev_b32 v106, 16, v150
    v_and_b32 v107, 0xffff0000, v150
    v_lshlrev_b32 v108, 16, v152
    v_and_b32 v109, 0xffff0000, v152
    v_lshlrev_b32 v110, 16, v154
    v_and_b32 v111, 0xffff0000, v154
    v_lshlrev_b32 v112, 16, v156
    v_and_b32 v113, 0xffff0000, v156
    v_pk_mul_f32 v[124:125], v[100:101], s[78:79]
    v_pk_fma_f32 v[124:125], v[102:103], s[76:77], v[124:125]
    v_pk_fma_f32 v[124:125], v[104:105], s[74:75], v[124:125]
    v_pk_fma_f32 v[124:125], v[106:107], s[72:73], v[124:125]
    v_pk_mul_f32 v[126:127], v[102:103], s[78:79]
    v_pk_fma_f32 v[126:127], v[104:105], s[76:77], v[126:127]
    v_pk_fma_f32 v[126:127], v[106:107], s[74:75], v[126:127]
    v_pk_fma_f32 v[126:127], v[108:109], s[72:73], v[126:127]
    v_pk_mul_f32 v[128:129], v[104:105], s[78:79]
    v_pk_fma_f32 v[128:129], v[106:107], s[76:77], v[128:129]
    v_pk_fma_f32 v[128:129], v[108:109], s[74:75], v[128:129]
    v_pk_fma_f32 v[128:129], v[110:111], s[72:73], v[128:129]
    v_pk_mul_f32 v[130:131], v[106:107], s[78:79]
    v_pk_fma_f32 v[130:131], v[108:109], s[76:77], v[130:131]
    v_pk_fma_f32 v[130:131], v[110:111], s[74:75], v[130:131]
    v_pk_fma_f32 v[130:131], v[112:113], s[72:73], v[130:131]
    s_waitcnt vmcnt(0)
    v_lshlrev_b32 v116, 16, v158
    v_and_b32 v117, 0xffff0000, v158
    v_pk_mul_f32 v[124:125], v[124:125], v[116:117]
    v_lshlrev_b32 v118, 16, v160
    v_and_b32 v119, 0xffff0000, v160
    v_pk_mul_f32 v[126:127], v[126:127], v[118:119]
    v_lshlrev_b32 v120, 16, v162
    v_and_b32 v121, 0xffff0000, v162
    v_pk_mul_f32 v[128:129], v[128:129], v[120:121]
    v_lshlrev_b32 v122, 16, v164
    v_and_b32 v123, 0xffff0000, v164
    v_pk_mul_f32 v[130:131], v[130:131], v[122:123]
    v_cvt_pk_bf16_f32 v132, v130, v128
    v_cvt_pk_bf16_f32 v133, v126, v124
    ds_write_b64 v42, v[132:133] offset:0
    v_cvt_pk_bf16_f32 v134, v131, v129
    v_cvt_pk_bf16_f32 v135, v127, v125
    ds_write_b64 v42, v[134:135] offset:4576
    v_lshlrev_b32 v100, 16, v145
    v_and_b32 v101, 0xffff0000, v145
    v_lshlrev_b32 v102, 16, v147
    v_and_b32 v103, 0xffff0000, v147
    v_lshlrev_b32 v104, 16, v149
    v_and_b32 v105, 0xffff0000, v149
    v_lshlrev_b32 v106, 16, v151
    v_and_b32 v107, 0xffff0000, v151
    v_lshlrev_b32 v108, 16, v153
    v_and_b32 v109, 0xffff0000, v153
    v_lshlrev_b32 v110, 16, v155
    v_and_b32 v111, 0xffff0000, v155
    v_lshlrev_b32 v112, 16, v157
    v_and_b32 v113, 0xffff0000, v157
    v_pk_mul_f32 v[124:125], v[100:101], s[86:87]
    v_pk_fma_f32 v[124:125], v[102:103], s[84:85], v[124:125]
    v_pk_fma_f32 v[124:125], v[104:105], s[82:83], v[124:125]
    v_pk_fma_f32 v[124:125], v[106:107], s[80:81], v[124:125]
    v_pk_mul_f32 v[126:127], v[102:103], s[86:87]
    v_pk_fma_f32 v[126:127], v[104:105], s[84:85], v[126:127]
    v_pk_fma_f32 v[126:127], v[106:107], s[82:83], v[126:127]
    v_pk_fma_f32 v[126:127], v[108:109], s[80:81], v[126:127]
    v_pk_mul_f32 v[128:129], v[104:105], s[86:87]
    v_pk_fma_f32 v[128:129], v[106:107], s[84:85], v[128:129]
    v_pk_fma_f32 v[128:129], v[108:109], s[82:83], v[128:129]
    v_pk_fma_f32 v[128:129], v[110:111], s[80:81], v[128:129]
    v_pk_mul_f32 v[130:131], v[106:107], s[86:87]
    v_pk_fma_f32 v[130:131], v[108:109], s[84:85], v[130:131]
    v_pk_fma_f32 v[130:131], v[110:111], s[82:83], v[130:131]
    v_pk_fma_f32 v[130:131], v[112:113], s[80:81], v[130:131]
    v_lshlrev_b32 v116, 16, v159
    v_and_b32 v117, 0xffff0000, v159
    v_pk_mul_f32 v[124:125], v[124:125], v[116:117]
    v_lshlrev_b32 v118, 16, v161
    v_and_b32 v119, 0xffff0000, v161
    v_pk_mul_f32 v[126:127], v[126:127], v[118:119]
    v_lshlrev_b32 v120, 16, v163
    v_and_b32 v121, 0xffff0000, v163
    v_pk_mul_f32 v[128:129], v[128:129], v[120:121]
    v_lshlrev_b32 v122, 16, v165
    v_and_b32 v123, 0xffff0000, v165
    v_pk_mul_f32 v[130:131], v[130:131], v[122:123]
    v_cvt_pk_bf16_f32 v136, v130, v128
    v_cvt_pk_bf16_f32 v137, v126, v124
    ds_write_b64 v42, v[136:137] offset:9152
    v_cvt_pk_bf16_f32 v138, v131, v129
    v_cvt_pk_bf16_f32 v139, v127, v125
    ds_write_b64 v42, v[138:139] offset:13728
    s_waitcnt lgkmcnt(0)
    s_barrier
    s_branch L_B_go
L_CONV:
    s_setprio 0
    ds_read_b128 v[228:231], v26 offset:2048
    ds_read_b128 v[224:227], v26 offset:2560
    ds_read_b128 v[220:223], v26 offset:3072
    ds_read_b128 v[216:219], v26 offset:3584
    ds_read_b128 v[212:215], v26 offset:2112
    s_waitcnt lgkmcnt(4)
    v_mfma_f32_16x16x32_bf16 v[44:47], v[248:251], v[228:231], 0
    ds_read_b128 v[208:211], v26 offset:2624
    s_waitcnt lgkmcnt(4)
    v_mfma_f32_16x16x32_bf16 v[40:43], v[248:251], v[224:227], 0
    ds_read_b128 v[204:207], v26 offset:3136
    s_waitcnt lgkmcnt(4)
    v_mfma_f32_16x16x32_bf16 v[36:39], v[248:251], v[220:223], 0
    ds_read_b128 v[200:203], v26 offset:3648
    s_waitcnt lgkmcnt(4)
    v_mfma_f32_16x16x32_bf16 v[32:35], v[248:251], v[216:219], 0
    ds_read_b64 v[196:197], v25 offset:576
    v_mfma_f32_16x16x32_bf16 v[44:47], v[244:247], v[224:227], v[44:47]
    ds_read_b64 v[198:199], v25 offset:584
    v_mfma_f32_16x16x32_bf16 v[40:43], v[244:247], v[220:223], v[40:43]
    ds_read_b64 v[192:193], v25 offset:1088
    v_mfma_f32_16x16x32_bf16 v[36:39], v[244:247], v[216:219], v[36:39]
    ds_read_b64 v[194:195], v25 offset:1096
    v_mfma_f32_16x16x32_bf16 v[44:47], v[240:243], v[220:223], v[44:47]
    ds_read_b64 v[188:189], v25 offset:1600
    v_mfma_f32_16x16x32_bf16 v[40:43], v[240:243], v[216:219], v[40:43]
    ds_read_b64 v[190:191], v25 offset:1608
    v_mfma_f32_16x16x32_bf16 v[44:47], v[236:239], v[216:219], v[44:47]
    ds_read_b64 v[184:185], v25 offset:128
    s_waitcnt lgkmcnt(10)
    v_mfma_f32_16x16x32_bf16 v[44:47], v[232:235], v[212:215], v[44:47]
    ds_read_b64 v[186:187], v25 offset:136
    s_waitcnt lgkmcnt(10)
    v_mfma_f32_16x16x32_bf16 v[40:43], v[232:235], v[208:211], v[40:43]
    ds_read_b128 v[180:183], v26 offset:2176
    s_waitcnt lgkmcnt(10)
    v_mfma_f32_16x16x32_bf16 v[36:39], v[232:235], v[204:207], v[36:39]
    ds_read_b128 v[176:179], v26 offset:2688
    s_waitcnt lgkmcnt(10)
    v_mfma_f32_16x16x32_bf16 v[32:35], v[232:235], v[200:203], v[32:35]
    ds_read_b128 v[172:175], v26 offset:3200
    s_waitcnt lgkmcnt(9)
    v_mfma_f32_16x16x32_bf16 v[44:47], v[196:199], v[208:211], v[44:47]
    ds_read_b128 v[168:171], v26 offset:3712
    v_mfma_f32_16x16x32_bf16 v[40:43], v[196:199], v[204:207], v[40:43]
    ds_read_b64 v[164:165], v25 offset:640
    ds_read_b64 v[166:167], v25 offset:648
    v_mfma_f32_16x16x32_bf16 v[36:39], v[196:199], v[200:203], v[36:39]
    ds_read_b64 v[160:161], v25 offset:1152
    s_waitcnt lgkmcnt(10)
    v_mfma_f32_16x16x32_bf16 v[44:47], v[192:195], v[204:207], v[44:47]
    ds_read_b64 v[162:163], v25 offset:1160
    v_mfma_f32_16x16x32_bf16 v[40:43], v[192:195], v[200:203], v[40:43]
    ds_read_b64 v[156:157], v25 offset:1664
    s_waitcnt lgkmcnt(10)
    v_mfma_f32_16x16x32_bf16 v[44:47], v[188:191], v[200:203], v[44:47]
    ds_read_b64 v[158:159], v25 offset:1672
    s_waitcnt lgkmcnt(9)
    v_mfma_f32_16x16x32_bf16 v[44:47], v[184:187], v[180:183], v[44:47]
    ds_read_b64 v[152:153], v25 offset:192
    s_waitcnt lgkmcnt(9)
    v_mfma_f32_16x16x32_bf16 v[40:43], v[184:187], v[176:179], v[40:43]
    ds_read_b64 v[154:155], v25 offset:200
    ds_read_b128 v[148:151], v26 offset:2240
    s_waitcnt lgkmcnt(10)
    v_mfma_f32_16x16x32_bf16 v[36:39], v[184:187], v[172:175], v[36:39]
    ds_read_b128 v[144:147], v26 offset:2752
    s_waitcnt lgkmcnt(10)
    v_mfma_f32_16x16x32_bf16 v[32:35], v[184:187], v[168:171], v[32:35]
    ds_read_b128 v[140:143], v26 offset:3264
    s_waitcnt lgkmcnt(9)
    v_mfma_f32_16x16x32_bf16 v[44:47], v[164:167], v[176:179], v[44:47]
    ds_read_b128 v[136:139], v26 offset:3776
    v_mfma_f32_16x16x32_bf16 v[40:43], v[164:167], v[172:175], v[40:43]
    ds_read_b64 v[132:133], v25 offset:704
    ds_read_b64 v[134:135], v25 offset:712
    v_mfma_f32_16x16x32_bf16 v[36:39], v[164:167], v[168:171], v[36:39]
    ds_read_b64 v[128:129], v25 offset:1216
    s_waitcnt lgkmcnt(10)
    v_mfma_f32_16x16x32_bf16 v[44:47], v[160:163], v[172:175], v[44:47]
    ds_read_b64 v[130:131], v25 offset:1224
    v_mfma_f32_16x16x32_bf16 v[40:43], v[160:163], v[168:171], v[40:43]
    ds_read_b64 v[124:125], v25 offset:1728
    s_waitcnt lgkmcnt(10)
    v_mfma_f32_16x16x32_bf16 v[44:47], v[156:159], v[168:171], v[44:47]
    ds_read_b64 v[126:127], v25 offset:1736
    s_waitcnt lgkmcnt(9)
    v_mfma_f32_16x16x32_bf16 v[44:47], v[152:155], v[148:151], v[44:47]
    ds_read_b64 v[120:121], v25 offset:256
    s_waitcnt lgkmcnt(9)
    v_mfma_f32_16x16x32_bf16 v[40:43], v[152:155], v[144:147], v[40:43]
    ds_read_b64 v[122:123], v25 offset:264
    ds_read_b128 v[116:119], v26 offset:2304
    s_waitcnt lgkmcnt(10)
    v_mfma_f32_16x16x32_bf16 v[36:39], v[152:155], v[140:143], v[36:39]
    ds_read_b128 v[112:115], v26 offset:2816
    s_waitcnt lgkmcnt(10)
    v_mfma_f32_16x16x32_bf16 v[32:35], v[152:155], v[136:139], v[32:35]
    ds_read_b128 v[108:111], v26 offset:3328
    s_waitcnt lgkmcnt(9)
    v_mfma_f32_16x16x32_bf16 v[44:47], v[132:135], v[144:147], v[44:47]
    ds_read_b128 v[104:107], v26 offset:3840
    v_mfma_f32_16x16x32_bf16 v[40:43], v[132:135], v[140:143], v[40:43]
    ds_read_b64 v[100:101], v25 offset:768
    ds_read_b64 v[102:103], v25 offset:776
    v_mfma_f32_16x16x32_bf16 v[36:39], v[132:135], v[136:139], v[36:39]
    ds_read_b64 v[96:97], v25 offset:1280
    s_waitcnt lgkmcnt(10)
    v_mfma_f32_16x16x32_bf16 v[44:47], v[128:131], v[140:143], v[44:47]
    ds_read_b64 v[98:99], v25 offset:1288
    v_mfma_f32_16x16x32_bf16 v[40:43], v[128:131], v[136:139], v[40:43]
    ds_read_b64 v[92:93], v25 offset:1792
    s_waitcnt lgkmcnt(10)
    v_mfma_f32_16x16x32_bf16 v[44:47], v[124:127], v[136:139], v[44:47]
    ds_read_b64 v[94:95], v25 offset:1800
    s_waitcnt lgkmcnt(9)
    v_mfma_f32_16x16x32_bf16 v[44:47], v[120:123], v[116:119], v[44:47]
    ds_read_b64 v[88:89], v25 offset:320
    s_waitcnt lgkmcnt(9)
    v_mfma_f32_16x16x32_bf16 v[40:43], v[120:123], v[112:115], v[40:43]
    ds_read_b64 v[90:91], v25 offset:328
    ds_read_b128 v[84:87], v26 offset:2368
    s_waitcnt lgkmcnt(10)
    v_mfma_f32_16x16x32_bf16 v[36:39], v[120:123], v[108:111], v[36:39]
    ds_read_b128 v[80:83], v26 offset:2880
    s_waitcnt lgkmcnt(10)
    v_mfma_f32_16x16x32_bf16 v[32:35], v[120:123], v[104:107], v[32:35]
    ds_read_b128 v[76:79], v26 offset:3392
    s_waitcnt lgkmcnt(9)
    v_mfma_f32_16x16x32_bf16 v[44:47], v[100:103], v[112:115], v[44:47]
    ds_read_b128 v[72:75], v26 offset:3904
    v_mfma_f32_16x16x32_bf16 v[40:43], v[100:103], v[108:111], v[40:43]
    ds_read_b64 v[68:69], v25 offset:832
    ds_read_b64 v[70:71], v25 offset:840
    v_mfma_f32_16x16x32_bf16 v[36:39], v[100:103], v[104:107], v[36:39]
    ds_read_b64 v[64:65], v25 offset:1344
    s_waitcnt lgkmcnt(10)
    v_mfma_f32_16x16x32_bf16 v[44:47], v[96:99], v[108:111], v[44:47]
    ds_read_b64 v[66:67], v25 offset:1352
    v_mfma_f32_16x16x32_bf16 v[40:43], v[96:99], v[104:107], v[40:43]
    ds_read_b64 v[228:229], v25 offset:1856
    s_waitcnt lgkmcnt(10)
    v_mfma_f32_16x16x32_bf16 v[44:47], v[92:95], v[104:107], v[44:47]
    ds_read_b64 v[230:231], v25 offset:1864
    s_waitcnt lgkmcnt(9)
    v_mfma_f32_16x16x32_bf16 v[44:47], v[88:91], v[84:87], v[44:47]
    ds_read_b64 v[248:249], v25 offset:384
    s_waitcnt lgkmcnt(9)
    v_mfma_f32_16x16x32_bf16 v[40:43], v[88:91], v[80:83], v[40:43]
    ds_read_b64 v[250:251], v25 offset:392
    ds_read_b128 v[224:227], v26 offset:2432
    s_waitcnt lgkmcnt(10)
    v_mfma_f32_16x16x32_bf16 v[36:39], v[88:91], v[76:79], v[36:39]
    ds_read_b128 v[244:247], v26 offset:2944
    s_waitcnt lgkmcnt(10)
    v_mfma_f32_16x16x32_bf16 v[32:35], v[88:91], v[72:75], v[32:35]
    ds_read_b128 v[220:223], v26 offset:3456
    s_waitcnt lgkmcnt(9)
    v_mfma_f32_16x16x32_bf16 v[44:47], v[68:71], v[80:83], v[44:47]
    ds_read_b128 v[240:243], v26 offset:3968
    v_mfma_f32_16x16x32_bf16 v[40:43], v[68:71], v[76:79], v[40:43]
    ds_read_b64 v[236:237], v25 offset:896
    ds_read_b64 v[238:239], v25 offset:904
    v_mfma_f32_16x16x32_bf16 v[36:39], v[68:71], v[72:75], v[36:39]
    ds_read_b64 v[216:217], v25 offset:1408
    s_waitcnt lgkmcnt(10)
    v_mfma_f32_16x16x32_bf16 v[44:47], v[64:67], v[76:79], v[44:47]
    ds_read_b64 v[218:219], v25 offset:1416
    v_mfma_f32_16x16x32_bf16 v[40:43], v[64:67], v[72:75], v[40:43]
    ds_read_b64 v[212:213], v25 offset:1920
    s_waitcnt lgkmcnt(10)
    v_mfma_f32_16x16x32_bf16 v[44:47], v[228:231], v[72:75], v[44:47]
    ds_read_b64 v[214:215], v25 offset:1928
    s_waitcnt lgkmcnt(9)
    v_mfma_f32_16x16x32_bf16 v[44:47], v[248:251], v[224:227], v[44:47]
    ds_read_b64 v[232:233], v25 offset:448
    s_waitcnt lgkmcnt(9)
    v_mfma_f32_16x16x32_bf16 v[40:43], v[248:251], v[244:247], v[40:43]
    ds_read_b64 v[234:235], v25 offset:456
    ds_read_b128 v[208:211], v26 offset:2496
    s_waitcnt lgkmcnt(10)
    v_mfma_f32_16x16x32_bf16 v[36:39], v[248:251], v[220:223], v[36:39]
    ds_read_b128 v[196:199], v26 offset:3008
    s_waitcnt lgkmcnt(10)
    v_mfma_f32_16x16x32_bf16 v[32:35], v[248:251], v[240:243], v[32:35]
    ds_read_b128 v[204:207], v26 offset:3520
    s_waitcnt lgkmcnt(9)
    v_mfma_f32_16x16x32_bf16 v[44:47], v[236:239], v[244:247], v[44:47]
    ds_read_b128 v[192:195], v26 offset:4032
    v_mfma_f32_16x16x32_bf16 v[40:43], v[236:239], v[220:223], v[40:43]
    ds_read_b64 v[188:189], v25 offset:960
    ds_read_b64 v[190:191], v25 offset:968
    v_mfma_f32_16x16x32_bf16 v[36:39], v[236:239], v[240:243], v[36:39]
    ds_read_b32 v12, v30
    s_waitcnt lgkmcnt(10)
    v_mfma_f32_16x16x32_bf16 v[44:47], v[216:219], v[220:223], v[44:47]
    ds_read_b64 v[200:201], v25 offset:1472
    v_mfma_f32_16x16x32_bf16 v[40:43], v[216:219], v[240:243], v[40:43]
    ds_read_b64 v[202:203], v25 offset:1480
    s_waitcnt lgkmcnt(10)
    v_mfma_f32_16x16x32_bf16 v[44:47], v[212:215], v[240:243], v[44:47]
    ds_read_b64 v[180:181], v25 offset:1984
    s_waitcnt lgkmcnt(9)
    v_mfma_f32_16x16x32_bf16 v[44:47], v[232:235], v[208:211], v[44:47]
    ds_read_b64 v[182:183], v25 offset:1992
    s_waitcnt lgkmcnt(9)
    v_mfma_f32_16x16x32_bf16 v[40:43], v[232:235], v[196:199], v[40:43]
    ds_read_b128 v[184:187], v26 offset:448
    s_waitcnt lgkmcnt(9)
    v_mfma_f32_16x16x32_bf16 v[36:39], v[232:235], v[204:207], v[36:39]
    ds_read_b128 v[176:179], v26 offset:960
    s_waitcnt lgkmcnt(9)
    v_mfma_f32_16x16x32_bf16 v[32:35], v[232:235], v[192:195], v[32:35]
    ds_read_b128 v[164:167], v26 offset:1472
    s_waitcnt lgkmcnt(8)
    v_mfma_f32_16x16x32_bf16 v[44:47], v[188:191], v[196:199], v[44:47]
    ds_read_b128 v[172:175], v26 offset:1984
    v_mfma_f32_16x16x32_bf16 v[40:43], v[188:191], v[204:207], v[40:43]
    s_waitcnt lgkmcnt(8)
    v_cmp_lt_u32 vcc, v12, v31
    s_nop 1
    s_cbranch_vccz L_gate_ok
L_gate_spin:
    s_sleep 1
    ds_read_b32 v12, v30
    s_waitcnt lgkmcnt(0)
    v_cmp_lt_u32 vcc, v12, v31
    s_nop 1
    s_cbranch_vccnz L_gate_spin
L_gate_ok:
    ds_read_b64 v[160:161], v25 offset:2496
    v_mfma_f32_16x16x32_bf16 v[36:39], v[188:191], v[192:195], v[36:39]
    ds_read_b64 v[162:163], v25 offset:2504
    s_waitcnt lgkmcnt(8)
    v_mfma_f32_16x16x32_bf16 v[44:47], v[200:203], v[204:207], v[44:47]
    v_cvt_pk_bf16_f32 v4, v32, v33
    v_cvt_pk_bf16_f32 v5, v34, v35
    v_mfma_f32_16x16x32_bf16 v[40:43], v[200:203], v[192:195], v[40:43]
    ds_write_b64 v27, v[4:5] offset:0
    s_waitcnt lgkmcnt(7)
    v_mfma_f32_16x16x32_bf16 v[44:47], v[180:183], v[192:195], v[44:47]
    ds_read_b64 v[156:157], v25 offset:3008
    s_waitcnt lgkmcnt(7)
    v_mfma_f32_16x16x32_bf16 v[60:63], v[232:235], v[184:187], 0
    v_cvt_pk_bf16_f32 v6, v36, v37
    v_cvt_pk_bf16_f32 v7, v38, v39
    s_waitcnt lgkmcnt(6)
    v_mfma_f32_16x16x32_bf16 v[56:59], v[232:235], v[176:179], 0
    ds_write_b64 v27, v[6:7] offset:576
    s_waitcnt lgkmcnt(6)
    v_mfma_f32_16x16x32_bf16 v[52:55], v[232:235], v[164:167], 0
    v_cvt_pk_bf16_f32 v8, v40, v41
    v_cvt_pk_bf16_f32 v9, v42, v43
    s_waitcnt lgkmcnt(5)
    v_mfma_f32_16x16x32_bf16 v[48:51], v[232:235], v[172:175], 0
    ds_write_b64 v27, v[8:9] offset:1152
    v_mfma_f32_16x16x32_bf16 v[60:63], v[188:191], v[176:179], v[60:63]
    v_cvt_pk_bf16_f32 v10, v44, v45
    v_cvt_pk_bf16_f32 v11, v46, v47
    v_mfma_f32_16x16x32_bf16 v[56:59], v[188:191], v[164:167], v[56:59]
    ds_write_b64 v27, v[10:11] offset:1728
    v_mfma_f32_16x16x32_bf16 v[52:55], v[188:191], v[172:175], v[52:55]
    s_mov_b64 exec, 1
    ds_add_u32 v28, v29
    s_mov_b64 exec, -1
    v_mfma_f32_16x16x32_bf16 v[48:51], v[188:191], v[208:211], v[48:51]
    ds_read_b64 v[158:159], v25 offset:3016
    v_mfma_f32_16x16x32_bf16 v[60:63], v[200:203], v[164:167], v[60:63]
    ds_read_b64 v[168:169], v25 offset:3520
    v_mfma_f32_16x16x32_bf16 v[56:59], v[200:203], v[172:175], v[56:59]
    ds_read_b64 v[170:171], v25 offset:3528
    v_mfma_f32_16x16x32_bf16 v[52:55], v[200:203], v[208:211], v[52:55]
    ds_read_b64 v[148:149], v25 offset:4032
    v_mfma_f32_16x16x32_bf16 v[48:51], v[200:203], v[196:199], v[48:51]
    ds_read_b64 v[150:151], v25 offset:4040
    v_mfma_f32_16x16x32_bf16 v[60:63], v[180:183], v[172:175], v[60:63]
    ds_read_b64 v[152:153], v25 offset:384
    v_mfma_f32_16x16x32_bf16 v[56:59], v[180:183], v[208:211], v[56:59]
    ds_read_b64 v[154:155], v25 offset:392
    v_mfma_f32_16x16x32_bf16 v[52:55], v[180:183], v[196:199], v[52:55]
    ds_read_b128 v[144:147], v26 offset:384
    v_mfma_f32_16x16x32_bf16 v[48:51], v[180:183], v[204:207], v[48:51]
    ds_read_b128 v[132:135], v26 offset:896
    s_waitcnt lgkmcnt(10)
    v_mfma_f32_16x16x32_bf16 v[60:63], v[160:163], v[208:211], v[60:63]
    ds_read_b128 v[140:143], v26 offset:1408
    v_mfma_f32_16x16x32_bf16 v[56:59], v[160:163], v[196:199], v[56:59]
    ds_read_b128 v[128:131], v26 offset:1920
    v_mfma_f32_16x16x32_bf16 v[52:55], v[160:163], v[204:207], v[52:55]
    ds_read_b64 v[124:125], v25 offset:896
    v_mfma_f32_16x16x32_bf16 v[48:51], v[160:163], v[192:195], v[48:51]
    ds_read_b64 v[126:127], v25 offset:904
    s_waitcnt lgkmcnt(10)
    v_mfma_f32_16x16x32_bf16 v[60:63], v[156:159], v[196:199], v[60:63]
    ds_read_b128 v[136:139], v26 offset:2432
    v_mfma_f32_16x16x32_bf16 v[56:59], v[156:159], v[204:207], v[56:59]
    ds_read_b64 v[116:117], v25 offset:1408
    v_mfma_f32_16x16x32_bf16 v[52:55], v[156:159], v[192:195], v[52:55]
    ds_read_b64 v[118:119], v25 offset:1416
    v_mfma_f32_16x16x32_bf16 v[60:63], v[168:171], v[204:207], v[60:63]
    ds_read_b128 v[120:123], v26 offset:2944
    v_mfma_f32_16x16x32_bf16 v[56:59], v[168:171], v[192:195], v[56:59]
    ds_read_b64 v[112:113], v25 offset:1920
    s_waitcnt lgkmcnt(10)
    v_mfma_f32_16x16x32_bf16 v[60:63], v[148:151], v[192:195], v[60:63]
    ds_read_b64 v[114:115], v25 offset:1928
    v_mfma_f32_16x16x32_bf16 v[60:63], v[152:155], v[144:147], v[60:63]
    ds_read_b128 v[100:103], v26 offset:3456
    s_waitcnt lgkmcnt(10)
    v_mfma_f32_16x16x32_bf16 v[56:59], v[152:155], v[132:135], v[56:59]
    ds_read_b64 v[108:109], v25 offset:2432
    v_mfma_f32_16x16x32_bf16 v[52:55], v[152:155], v[140:143], v[52:55]
    ds_read_b64 v[110:111], v25 offset:2440
    s_waitcnt lgkmcnt(10)
    v_mfma_f32_16x16x32_bf16 v[48:51], v[152:155], v[128:131], v[48:51]
    ds_read_b128 v[96:99], v26 offset:3968
    s_waitcnt lgkmcnt(10)
    v_mfma_f32_16x16x32_bf16 v[60:63], v[124:127], v[132:135], v[60:63]
    ds_read_b64 v[92:93], v25 offset:2944
    v_mfma_f32_16x16x32_bf16 v[56:59], v[124:127], v[140:143], v[56:59]
    ds_read_b64 v[94:95], v25 offset:2952
    v_mfma_f32_16x16x32_bf16 v[52:55], v[124:127], v[128:131], v[52:55]
    ds_read_b64 v[104:105], v25 offset:3456
    s_waitcnt lgkmcnt(10)
    v_mfma_f32_16x16x32_bf16 v[48:51], v[124:127], v[136:139], v[48:51]
    ds_read_b64 v[106:107], v25 offset:3464
    v_mfma_f32_16x16x32_bf16 v[60:63], v[116:119], v[140:143], v[60:63]
    ds_read_b64 v[84:85], v25 offset:3968
    v_mfma_f32_16x16x32_bf16 v[56:59], v[116:119], v[128:131], v[56:59]
    ds_read_b64 v[86:87], v25 offset:3976
    v_mfma_f32_16x16x32_bf16 v[52:55], v[116:119], v[136:139], v[52:55]
    ds_read_b64 v[88:89], v25 offset:320
    s_waitcnt lgkmcnt(10)
    v_mfma_f32_16x16x32_bf16 v[48:51], v[116:119], v[120:123], v[48:51]
    ds_read_b64 v[90:91], v25 offset:328
    v_mfma_f32_16x16x32_bf16 v[60:63], v[112:115], v[128:131], v[60:63]
    ds_read_b128 v[80:83], v26 offset:320
    v_mfma_f32_16x16x32_bf16 v[56:59], v[112:115], v[136:139], v[56:59]
    ds_read_b128 v[68:71], v26 offset:832
    v_mfma_f32_16x16x32_bf16 v[52:55], v[112:115], v[120:123], v[52:55]
    ds_read_b128 v[76:79], v26 offset:1344
    v_mfma_f32_16x16x32_bf16 v[48:51], v[112:115], v[100:103], v[48:51]
    ds_read_b128 v[64:67], v26 offset:1856
    s_waitcnt lgkmcnt(10)
    v_mfma_f32_16x16x32_bf16 v[60:63], v[108:111], v[136:139], v[60:63]
    ds_read_b64 v[228:229], v25 offset:832
    v_mfma_f32_16x16x32_bf16 v[56:59], v[108:111], v[120:123], v[56:59]
    ds_read_b64 v[230:231], v25 offset:840
    v_mfma_f32_16x16x32_bf16 v[52:55], v[108:111], v[100:103], v[52:55]
    ds_read_b128 v[72:75], v26 offset:2368
    v_mfma_f32_16x16x32_bf16 v[48:51], v[108:111], v[96:99], v[48:51]
    ds_read_b64 v[224:225], v25 offset:1344
    v_mfma_f32_16x16x32_bf16 v[60:63], v[92:95], v[120:123], v[60:63]
    ds_read_b64 v[226:227], v25 offset:1352
    v_mfma_f32_16x16x32_bf16 v[56:59], v[92:95], v[100:103], v[56:59]
    ds_read_b128 v[248:251], v26 offset:2880
    v_mfma_f32_16x16x32_bf16 v[52:55], v[92:95], v[96:99], v[52:55]
    ds_read_b64 v[244:245], v25 offset:1856
    s_waitcnt lgkmcnt(10)
    v_mfma_f32_16x16x32_bf16 v[60:63], v[104:107], v[100:103], v[60:63]
    ds_read_b64 v[246:247], v25 offset:1864
    v_mfma_f32_16x16x32_bf16 v[56:59], v[104:107], v[96:99], v[56:59]
    ds_read_b128 v[236:239], v26 offset:3392
    v_mfma_f32_16x16x32_bf16 v[60:63], v[84:87], v[96:99], v[60:63]
    ds_read_b64 v[220:221], v25 offset:2368
    v_mfma_f32_16x16x32_bf16 v[60:63], v[88:91], v[80:83], v[60:63]
    ds_read_b64 v[222:223], v25 offset:2376
    s_waitcnt lgkmcnt(10)
    v_mfma_f32_16x16x32_bf16 v[56:59], v[88:91], v[68:71], v[56:59]
    ds_read_b128 v[216:219], v26 offset:3904
    v_mfma_f32_16x16x32_bf16 v[52:55], v[88:91], v[76:79], v[52:55]
    ds_read_b64 v[212:213], v25 offset:2880
    v_mfma_f32_16x16x32_bf16 v[48:51], v[88:91], v[64:67], v[48:51]
    ds_read_b64 v[214:215], v25 offset:2888
    s_waitcnt lgkmcnt(10)
    v_mfma_f32_16x16x32_bf16 v[60:63], v[228:231], v[68:71], v[60:63]
    ds_read_b64 v[240:241], v25 offset:3392
    v_mfma_f32_16x16x32_bf16 v[56:59], v[228:231], v[76:79], v[56:59]
    ds_read_b64 v[242:243], v25 offset:3400
    v_mfma_f32_16x16x32_bf16 v[52:55], v[228:231], v[64:67], v[52:55]
    ds_read_b64 v[184:185], v25 offset:3904
    v_mfma_f32_16x16x32_bf16 v[48:51], v[228:231], v[72:75], v[48:51]
    ds_read_b64 v[186:187], v25 offset:3912
    s_waitcnt lgkmcnt(10)
    v_mfma_f32_16x16x32_bf16 v[60:63], v[224:227], v[76:79], v[60:63]
    ds_read_b64 v[232:233], v25 offset:256
    v_mfma_f32_16x16x32_bf16 v[56:59], v[224:227], v[64:67], v[56:59]
    ds_read_b64 v[234:235], v25 offset:264
    v_mfma_f32_16x16x32_bf16 v[52:55], v[224:227], v[72:75], v[52:55]
    ds_read_b128 v[176:179], v26 offset:256
    v_mfma_f32_16x16x32_bf16 v[48:51], v[224:227], v[248:251], v[48:51]
    ds_read_b128 v[188:191], v26 offset:768
    v_mfma_f32_16x16x32_bf16 v[60:63], v[244:247], v[64:67], v[60:63]
    ds_read_b128 v[164:167], v26 offset:1280
    v_mfma_f32_16x16x32_bf16 v[56:59], v[244:247], v[72:75], v[56:59]
    ds_read_b128 v[200:203], v26 offset:1792
    v_mfma_f32_16x16x32_bf16 v[52:55], v[244:247], v[248:251], v[52:55]
    ds_read_b64 v[172:173], v25 offset:768
    s_waitcnt lgkmcnt(10)
    v_mfma_f32_16x16x32_bf16 v[48:51], v[244:247], v[236:239], v[48:51]
    ds_read_b64 v[174:175], v25 offset:776
    v_mfma_f32_16x16x32_bf16 v[60:63], v[220:223], v[72:75], v[60:63]
    ds_read_b128 v[180:183], v26 offset:2304
    v_mfma_f32_16x16x32_bf16 v[56:59], v[220:223], v[248:251], v[56:59]
    ds_read_b64 v[208:209], v25 offset:1280
    v_mfma_f32_16x16x32_bf16 v[52:55], v[220:223], v[236:239], v[52:55]
    ds_read_b64 v[210:211], v25 offset:1288
    v_mfma_f32_16x16x32_bf16 v[48:51], v[220:223], v[216:219], v[48:51]
    ds_read_b128 v[160:163], v26 offset:2816
    v_mfma_f32_16x16x32_bf16 v[60:63], v[212:215], v[248:251], v[60:63]
    ds_read_b64 v[196:197], v25 offset:1792
    v_mfma_f32_16x16x32_bf16 v[56:59], v[212:215], v[236:239], v[56:59]
    ds_read_b64 v[198:199], v25 offset:1800
    v_mfma_f32_16x16x32_bf16 v[52:55], v[212:215], v[216:219], v[52:55]
    ds_read_b128 v[156:159], v26 offset:3328
    s_waitcnt lgkmcnt(10)
    v_mfma_f32_16x16x32_bf16 v[60:63], v[240:243], v[236:239], v[60:63]
    ds_read_b64 v[204:205], v25 offset:2304
    v_mfma_f32_16x16x32_bf16 v[56:59], v[240:243], v[216:219], v[56:59]
    ds_read_b64 v[206:207], v25 offset:2312
    v_mfma_f32_16x16x32_bf16 v[60:63], v[184:187], v[216:219], v[60:63]
    ds_read_b128 v[168:171], v26 offset:3840
    v_mfma_f32_16x16x32_bf16 v[60:63], v[232:235], v[176:179], v[60:63]
    ds_read_b64 v[148:149], v25 offset:2816
    v_mfma_f32_16x16x32_bf16 v[56:59], v[232:235], v[188:191], v[56:59]
    ds_read_b64 v[150:151], v25 offset:2824
    v_mfma_f32_16x16x32_bf16 v[52:55], v[232:235], v[164:167], v[52:55]
    ds_read_b64 v[192:193], v25 offset:3328
    s_waitcnt lgkmcnt(10)
    v_mfma_f32_16x16x32_bf16 v[48:51], v[232:235], v[200:203], v[48:51]
    ds_read_b64 v[194:195], v25 offset:3336
    v_mfma_f32_16x16x32_bf16 v[60:63], v[172:175], v[188:191], v[60:63]
    ds_read_b64 v[144:145], v25 offset:3840
    v_mfma_f32_16x16x32_bf16 v[56:59], v[172:175], v[164:167], v[56:59]
    ds_read_b64 v[146:147], v25 offset:3848
    v_mfma_f32_16x16x32_bf16 v[52:55], v[172:175], v[200:203], v[52:55]
    ds_read_b64 v[152:153], v25 offset:192
    v_mfma_f32_16x16x32_bf16 v[48:51], v[172:175], v[180:183], v[48:51]
    ds_read_b64 v[154:155], v25 offset:200
    v_mfma_f32_16x16x32_bf16 v[60:63], v[208:211], v[164:167], v[60:63]
    ds_read_b128 v[132:135], v26 offset:192
    v_mfma_f32_16x16x32_bf16 v[56:59], v[208:211], v[200:203], v[56:59]
    ds_read_b128 v[124:127], v26 offset:704
    v_mfma_f32_16x16x32_bf16 v[52:55], v[208:211], v[180:183], v[52:55]
    ds_read_b128 v[140:143], v26 offset:1216
    s_waitcnt lgkmcnt(10)
    v_mfma_f32_16x16x32_bf16 v[48:51], v[208:211], v[160:163], v[48:51]
    ds_read_b128 v[116:119], v26 offset:1728
    v_mfma_f32_16x16x32_bf16 v[60:63], v[196:199], v[200:203], v[60:63]
    ds_read_b64 v[128:129], v25 offset:704
    v_mfma_f32_16x16x32_bf16 v[56:59], v[196:199], v[180:183], v[56:59]
    ds_read_b64 v[130:131], v25 offset:712
    v_mfma_f32_16x16x32_bf16 v[52:55], v[196:199], v[160:163], v[52:55]
    ds_read_b128 v[112:115], v26 offset:2240
    v_mfma_f32_16x16x32_bf16 v[48:51], v[196:199], v[156:159], v[48:51]
    ds_read_b64 v[136:137], v25 offset:1216
    v_mfma_f32_16x16x32_bf16 v[60:63], v[204:207], v[180:183], v[60:63]
    ds_read_b64 v[138:139], v25 offset:1224
    v_mfma_f32_16x16x32_bf16 v[56:59], v[204:207], v[160:163], v[56:59]
    ds_read_b128 v[108:111], v26 offset:2752
    v_mfma_f32_16x16x32_bf16 v[52:55], v[204:207], v[156:159], v[52:55]
    ds_read_b64 v[120:121], v25 offset:1728
    v_mfma_f32_16x16x32_bf16 v[48:51], v[204:207], v[168:171], v[48:51]
    ds_read_b64 v[122:123], v25 offset:1736
    s_waitcnt lgkmcnt(10)
    v_mfma_f32_16x16x32_bf16 v[60:63], v[148:151], v[160:163], v[60:63]
    ds_read_b128 v[92:95], v26 offset:3264
    v_mfma_f32_16x16x32_bf16 v[56:59], v[148:151], v[156:159], v[56:59]
    ds_read_b64 v[100:101], v25 offset:2240
    v_mfma_f32_16x16x32_bf16 v[52:55], v[148:151], v[168:171], v[52:55]
    ds_read_b64 v[102:103], v25 offset:2248
    v_mfma_f32_16x16x32_bf16 v[60:63], v[192:195], v[156:159], v[60:63]
    ds_read_b128 v[104:107], v26 offset:3776
    v_mfma_f32_16x16x32_bf16 v[56:59], v[192:195], v[168:171], v[56:59]
    ds_read_b64 v[84:85], v25 offset:2752
    v_mfma_f32_16x16x32_bf16 v[60:63], v[144:147], v[168:171], v[60:63]
    ds_read_b64 v[86:87], v25 offset:2760
    v_mfma_f32_16x16x32_bf16 v[60:63], v[152:155], v[132:135], v[60:63]
    ds_read_b64 v[96:97], v25 offset:3264
    v_mfma_f32_16x16x32_bf16 v[56:59], v[152:155], v[124:127], v[56:59]
    ds_read_b64 v[98:99], v25 offset:3272
    s_waitcnt lgkmcnt(10)
    v_mfma_f32_16x16x32_bf16 v[52:55], v[152:155], v[140:143], v[52:55]
    ds_read_b64 v[80:81], v25 offset:3776
    v_mfma_f32_16x16x32_bf16 v[48:51], v[152:155], v[116:119], v[48:51]
    ds_read_b64 v[82:83], v25 offset:3784
    v_mfma_f32_16x16x32_bf16 v[60:63], v[128:131], v[124:127], v[60:63]
    ds_read_b64 v[88:89], v25 offset:128
    v_mfma_f32_16x16x32_bf16 v[56:59], v[128:131], v[140:143], v[56:59]
    ds_read_b64 v[90:91], v25 offset:136
    v_mfma_f32_16x16x32_bf16 v[52:55], v[128:131], v[116:119], v[52:55]
    ds_read_b128 v[68:71], v26 offset:1664
    v_mfma_f32_16x16x32_bf16 v[48:51], v[128:131], v[112:115], v[48:51]
    ds_read_b64 v[228:229], v25 offset:640
    v_mfma_f32_16x16x32_bf16 v[60:63], v[136:139], v[140:143], v[60:63]
    ds_read_b64 v[230:231], v25 offset:648
    v_mfma_f32_16x16x32_bf16 v[56:59], v[136:139], v[116:119], v[56:59]
    ds_read_b128 v[76:79], v26 offset:2176
    v_mfma_f32_16x16x32_bf16 v[52:55], v[136:139], v[112:115], v[52:55]
    ds_read_b64 v[224:225], v25 offset:1152
    v_mfma_f32_16x16x32_bf16 v[48:51], v[136:139], v[108:111], v[48:51]
    ds_read_b64 v[226:227], v25 offset:1160
    s_waitcnt lgkmcnt(10)
    v_mfma_f32_16x16x32_bf16 v[60:63], v[120:123], v[116:119], v[60:63]
    ds_read_b128 v[64:67], v26 offset:2688
    v_mfma_f32_16x16x32_bf16 v[56:59], v[120:123], v[112:115], v[56:59]
    ds_read_b64 v[244:245], v25 offset:1664
    v_mfma_f32_16x16x32_bf16 v[52:55], v[120:123], v[108:111], v[52:55]
    ds_read_b64 v[246:247], v25 offset:1672
    v_mfma_f32_16x16x32_bf16 v[48:51], v[120:123], v[92:95], v[48:51]
    ds_read_b128 v[72:75], v26 offset:3200
    v_mfma_f32_16x16x32_bf16 v[60:63], v[100:103], v[112:115], v[60:63]
    ds_read_b64 v[220:221], v25 offset:2176
    v_mfma_f32_16x16x32_bf16 v[56:59], v[100:103], v[108:111], v[56:59]
    ds_read_b64 v[222:223], v25 offset:2184
    v_mfma_f32_16x16x32_bf16 v[52:55], v[100:103], v[92:95], v[52:55]
    ds_read_b128 v[248:251], v26 offset:3712
    v_mfma_f32_16x16x32_bf16 v[48:51], v[100:103], v[104:107], v[48:51]
    ds_read_b64 v[212:213], v25 offset:64
    v_mfma_f32_16x16x32_bf16 v[60:63], v[84:87], v[108:111], v[60:63]
    ds_read_b64 v[214:215], v25 offset:72
    v_mfma_f32_16x16x32_bf16 v[56:59], v[84:87], v[92:95], v[56:59]
    ds_read_b128 v[236:239], v26 offset:1600
    v_mfma_f32_16x16x32_bf16 v[52:55], v[84:87], v[104:107], v[52:55]
    ds_read_b64 v[240:241], v25 offset:576
    v_mfma_f32_16x16x32_bf16 v[60:63], v[96:99], v[92:95], v[60:63]
    ds_read_b64 v[242:243], v25 offset:584
    ds_read_b128 v[184:187], v26 offset:2112
    v_mfma_f32_16x16x32_bf16 v[56:59], v[96:99], v[104:107], v[56:59]
    ds_read_b64 v[216:217], v25 offset:1088
    ds_read_b64 v[218:219], v25 offset:1096
    ds_read_b128 v[176:179], v26 offset:2624
    s_waitcnt lgkmcnt(10)
    v_mfma_f32_16x16x32_bf16 v[60:63], v[80:83], v[104:107], v[60:63]
    ds_read_b64 v[232:233], v25 offset:1600
    ds_read_b64 v[234:235], v25 offset:1608
    ds_read_b128 v[188:191], v26 offset:3136
    v_mfma_f32_16x16x32_bf16 v[48:51], v[88:91], v[68:71], v[48:51]
    ds_read_b64 v[172:173], v25 offset:2112
    ds_read_b64 v[174:175], v25 offset:2120
    ds_read_b128 v[164:167], v26 offset:3648
    v_mfma_f32_16x16x32_bf16 v[48:51], v[228:231], v[76:79], v[48:51]
    ds_read_b64 v[208:209], v25 offset:0
    ds_read_b64 v[210:211], v25 offset:8
    ds_read_b128 v[200:203], v26 offset:1536
    v_mfma_f32_16x16x32_bf16 v[48:51], v[224:227], v[64:67], v[48:51]
    ds_read_b64 v[196:197], v25 offset:512
    ds_read_b64 v[198:199], v25 offset:520
    ds_read_b128 v[180:183], v26 offset:2048
    v_mfma_f32_16x16x32_bf16 v[48:51], v[244:247], v[72:75], v[48:51]
    ds_read_b64 v[204:205], v25 offset:1024
    ds_read_b64 v[206:207], v25 offset:1032
    ds_read_b128 v[160:163], v26 offset:2560
    s_waitcnt lgkmcnt(10)
    v_mfma_f32_16x16x32_bf16 v[48:51], v[220:223], v[248:251], v[48:51]
    ds_read_b64 v[148:149], v25 offset:1536
    ds_read_b64 v[150:151], v25 offset:1544
    ds_read_b128 v[156:159], v26 offset:3072
    v_mfma_f32_16x16x32_bf16 v[48:51], v[212:215], v[236:239], v[48:51]
    ds_read_b64 v[192:193], v25 offset:2048
    ds_read_b64 v[194:195], v25 offset:2056
    ds_read_b128 v[144:147], v26 offset:3584
    v_mfma_f32_16x16x32_bf16 v[48:51], v[240:243], v[184:187], v[48:51]
    ds_read_b128 v[168:171], v26 offset:1152
    v_mfma_f32_16x16x32_bf16 v[48:51], v[216:219], v[176:179], v[48:51]
    ds_read_b64 v[132:133], v25 offset:2688
    v_mfma_f32_16x16x32_bf16 v[48:51], v[232:235], v[188:191], v[48:51]
    ds_read_b64 v[134:135], v25 offset:2696
    s_waitcnt lgkmcnt(10)
    v_mfma_f32_16x16x32_bf16 v[48:51], v[172:175], v[164:167], v[48:51]
    ds_read_b128 v[152:155], v26 offset:1088
    v_mfma_f32_16x16x32_bf16 v[48:51], v[208:211], v[200:203], v[48:51]
    ds_read_b64 v[124:125], v25 offset:2624
    v_mfma_f32_16x16x32_bf16 v[48:51], v[196:199], v[180:183], v[48:51]
    ds_read_b64 v[126:127], v25 offset:2632
    s_waitcnt lgkmcnt(10)
    v_mfma_f32_16x16x32_bf16 v[48:51], v[204:207], v[160:163], v[48:51]
    ds_read_b128 v[128:131], v26 offset:1024
    s_waitcnt lgkmcnt(10)
    v_mfma_f32_16x16x32_bf16 v[48:51], v[148:151], v[156:159], v[48:51]
    ds_read_b64 v[140:141], v25 offset:2560
    s_waitcnt lgkmcnt(8)
    v_mfma_f32_16x16x32_bf16 v[48:51], v[192:195], v[144:147], v[48:51]
    ds_read_b64 v[142:143], v25 offset:2568
    s_waitcnt lgkmcnt(8)
    v_mfma_f32_16x16x32_bf16 v[52:55], v[88:91], v[168:171], v[52:55]
    ds_read_b128 v[136:139], v26 offset:640
    v_mfma_f32_16x16x32_bf16 v[52:55], v[228:231], v[68:71], v[52:55]
    ds_read_b64 v[116:117], v25 offset:3200
    v_mfma_f32_16x16x32_bf16 v[52:55], v[224:227], v[76:79], v[52:55]
    ds_read_b64 v[118:119], v25 offset:3208
    v_mfma_f32_16x16x32_bf16 v[52:55], v[244:247], v[64:67], v[52:55]
    v_cvt_pk_bf16_f32 v4, v48, v49
    v_cvt_pk_bf16_f32 v5, v50, v51
    v_mfma_f32_16x16x32_bf16 v[52:55], v[220:223], v[72:75], v[52:55]
    ds_write_b64 v27, v[4:5] offset:2304
    s_waitcnt lgkmcnt(10)
    v_mfma_f32_16x16x32_bf16 v[52:55], v[132:135], v[248:251], v[52:55]
    s_mov_b64 exec, 1
    ds_add_u32 v28, v29
    s_mov_b64 exec, -1
    s_waitcnt lgkmcnt(10)
    v_mfma_f32_16x16x32_bf16 v[52:55], v[212:215], v[152:155], v[52:55]
    ds_read_b128 v[120:123], v26 offset:576
    v_mfma_f32_16x16x32_bf16 v[52:55], v[240:243], v[236:239], v[52:55]
    ds_read_b64 v[112:113], v25 offset:3136
    v_mfma_f32_16x16x32_bf16 v[52:55], v[216:219], v[184:187], v[52:55]
    ds_read_b64 v[114:115], v25 offset:3144
    v_mfma_f32_16x16x32_bf16 v[52:55], v[232:235], v[176:179], v[52:55]
    ds_read_b128 v[100:103], v26 offset:512
    v_mfma_f32_16x16x32_bf16 v[52:55], v[172:175], v[188:191], v[52:55]
    ds_read_b64 v[108:109], v25 offset:3072
    s_waitcnt lgkmcnt(10)
    v_mfma_f32_16x16x32_bf16 v[52:55], v[124:127], v[164:167], v[52:55]
    ds_read_b64 v[110:111], v25 offset:3080
    v_mfma_f32_16x16x32_bf16 v[52:55], v[208:211], v[128:131], v[52:55]
    ds_read_b128 v[84:87], v26 offset:128
    v_mfma_f32_16x16x32_bf16 v[52:55], v[196:199], v[200:203], v[52:55]
    ds_read_b64 v[92:93], v25 offset:3712
    v_mfma_f32_16x16x32_bf16 v[52:55], v[204:207], v[180:183], v[52:55]
    ds_read_b64 v[94:95], v25 offset:3720
    v_mfma_f32_16x16x32_bf16 v[52:55], v[148:151], v[160:163], v[52:55]
    ds_read_b128 v[96:99], v26 offset:64
    v_mfma_f32_16x16x32_bf16 v[52:55], v[192:195], v[156:159], v[52:55]
    ds_read_b64 v[80:81], v25 offset:3648
    v_mfma_f32_16x16x32_bf16 v[52:55], v[140:143], v[144:147], v[52:55]
    ds_read_b64 v[82:83], v25 offset:3656
    s_waitcnt lgkmcnt(10)
    v_mfma_f32_16x16x32_bf16 v[56:59], v[88:91], v[136:139], v[56:59]
    ds_read_b128 v[104:107], v26 offset:0
    v_mfma_f32_16x16x32_bf16 v[56:59], v[228:231], v[168:171], v[56:59]
    v_mfma_f32_16x16x32_bf16 v[56:59], v[224:227], v[68:71], v[56:59]
    v_mfma_f32_16x16x32_bf16 v[56:59], v[244:247], v[76:79], v[56:59]
    s_nop 0
    v_cvt_pk_bf16_f32 v6, v52, v53
    v_cvt_pk_bf16_f32 v7, v54, v55
    v_mfma_f32_16x16x32_bf16 v[56:59], v[220:223], v[64:67], v[56:59]
    ds_write_b64 v27, v[6:7] offset:2880
    v_mfma_f32_16x16x32_bf16 v[56:59], v[132:135], v[72:75], v[56:59]
    s_mov_b64 exec, 1
    ds_add_u32 v28, v29
    s_mov_b64 exec, -1
    v_mfma_f32_16x16x32_bf16 v[56:59], v[116:119], v[248:251], v[56:59]
    v_mfma_f32_16x16x32_bf16 v[56:59], v[212:215], v[120:123], v[56:59]
    v_mfma_f32_16x16x32_bf16 v[56:59], v[240:243], v[152:155], v[56:59]
    v_mfma_f32_16x16x32_bf16 v[56:59], v[216:219], v[236:239], v[56:59]
    v_mfma_f32_16x16x32_bf16 v[56:59], v[232:235], v[184:187], v[56:59]
    v_mfma_f32_16x16x32_bf16 v[56:59], v[172:175], v[176:179], v[56:59]
    v_mfma_f32_16x16x32_bf16 v[56:59], v[124:127], v[188:191], v[56:59]
    s_waitcnt lgkmcnt(10)
    v_mfma_f32_16x16x32_bf16 v[56:59], v[112:115], v[164:167], v[56:59]
    v_mfma_f32_16x16x32_bf16 v[56:59], v[208:211], v[100:103], v[56:59]
    v_mfma_f32_16x16x32_bf16 v[56:59], v[196:199], v[128:131], v[56:59]
    v_mfma_f32_16x16x32_bf16 v[56:59], v[204:207], v[200:203], v[56:59]
    v_mfma_f32_16x16x32_bf16 v[56:59], v[148:151], v[180:183], v[56:59]
    v_mfma_f32_16x16x32_bf16 v[56:59], v[192:195], v[160:163], v[56:59]
    v_mfma_f32_16x16x32_bf16 v[56:59], v[140:143], v[156:159], v[56:59]
    s_waitcnt lgkmcnt(9)
    v_mfma_f32_16x16x32_bf16 v[56:59], v[108:111], v[144:147], v[56:59]
    s_waitcnt lgkmcnt(8)
    v_mfma_f32_16x16x32_bf16 v[60:63], v[88:91], v[84:87], v[60:63]
    ds_read_b64 v[88:89], v25 offset:3584
    v_mfma_f32_16x16x32_bf16 v[60:63], v[228:231], v[136:139], v[60:63]
    ds_read_b64 v[90:91], v25 offset:3592
    v_mfma_f32_16x16x32_bf16 v[60:63], v[224:227], v[168:171], v[60:63]
    v_mfma_f32_16x16x32_bf16 v[60:63], v[244:247], v[68:71], v[60:63]
    s_nop 0
    v_cvt_pk_bf16_f32 v8, v56, v57
    v_cvt_pk_bf16_f32 v9, v58, v59
    v_mfma_f32_16x16x32_bf16 v[60:63], v[220:223], v[76:79], v[60:63]
    ds_write_b64 v27, v[8:9] offset:3456
    v_mfma_f32_16x16x32_bf16 v[60:63], v[132:135], v[64:67], v[60:63]
    s_mov_b64 exec, 1
    ds_add_u32 v28, v29
    s_mov_b64 exec, -1
    v_mfma_f32_16x16x32_bf16 v[60:63], v[116:119], v[72:75], v[60:63]
    s_waitcnt lgkmcnt(10)
    v_mfma_f32_16x16x32_bf16 v[60:63], v[92:95], v[248:251], v[60:63]
    s_waitcnt lgkmcnt(9)
    v_mfma_f32_16x16x32_bf16 v[60:63], v[212:215], v[96:99], v[60:63]
    v_mfma_f32_16x16x32_bf16 v[60:63], v[240:243], v[120:123], v[60:63]
    v_mfma_f32_16x16x32_bf16 v[60:63], v[216:219], v[152:155], v[60:63]
    v_mfma_f32_16x16x32_bf16 v[60:63], v[232:235], v[236:239], v[60:63]
    v_mfma_f32_16x16x32_bf16 v[60:63], v[172:175], v[184:187], v[60:63]
    v_mfma_f32_16x16x32_bf16 v[60:63], v[124:127], v[176:179], v[60:63]
    v_mfma_f32_16x16x32_bf16 v[60:63], v[112:115], v[188:191], v[60:63]
    s_waitcnt lgkmcnt(7)
    v_mfma_f32_16x16x32_bf16 v[60:63], v[80:83], v[164:167], v[60:63]
    s_waitcnt lgkmcnt(6)
    v_mfma_f32_16x16x32_bf16 v[60:63], v[208:211], v[104:107], v[60:63]
    v_mfma_f32_16x16x32_bf16 v[60:63], v[196:199], v[100:103], v[60:63]
    v_mfma_f32_16x16x32_bf16 v[60:63], v[204:207], v[128:131], v[60:63]
    v_mfma_f32_16x16x32_bf16 v[60:63], v[148:151], v[200:203], v[60:63]
    v_mfma_f32_16x16x32_bf16 v[60:63], v[192:195], v[180:183], v[60:63]
    v_mfma_f32_16x16x32_bf16 v[60:63], v[140:143], v[160:163], v[60:63]
    v_mfma_f32_16x16x32_bf16 v[60:63], v[108:111], v[156:159], v[60:63]
    s_waitcnt lgkmcnt(2)
    v_mfma_f32_16x16x32_bf16 v[60:63], v[88:91], v[144:147], v[60:63]
    s_nop 7
    v_cvt_pk_bf16_f32 v10, v60, v61
    v_cvt_pk_bf16_f32 v11, v62, v63
    ds_write_b64 v27, v[10:11] offset:4032
    s_mov_b64 exec, 1
    ds_add_u32 v28, v29
    s_mov_b64 exec, -1
    s_endpgm
L_HELP:
    s_lshl_b32 s3, s88, 6
    v_add_u32 v2, s3, v1
    s_lshl_b32 s3, s6, 3
    v_mul_u32_u24 v6, 896, v2
    v_add_u32 v6, s3, v6
    s_mul_i32 s42, s94, 896
    s_add_u32 s3, s3, s42
    v_mul_u32_u24 v5, 1792, v2
    v_add_u32 v5, s3, v5
    s_mov_b32 s64, 0
    s_mov_b32 s8, 0
    s_mov_b32 s65, 229376
    s_mov_b32 s9, 458752
    s_mov_b32 s66, 458752
    s_mov_b32 s10, 917504
    s_mov_b32 s67, 688128
    s_mov_b32 s11, 1376256
    s_mov_b32 s68, 917504
    s_mov_b32 s12, 1835008
    s_mov_b32 s69, 1146880
    s_mov_b32 s13, 2293760
    s_mov_b32 s70, 1376256
    s_mov_b32 s14, 2752512
    s_mov_b32 s71, 1605632
    s_mov_b32 s15, 3211264
L_HELP2:
    s_setprio 3
    v_bfe_u32 v2, v1, 2, 2
    v_mul_u32_u24 v2, 4672, v2
    v_and_b32 v3, 3, v1
    v_mul_u32_u24 v3, 144, v3
    v_add_u32 v2, v2, v3
    v_lshrrev_b32 v3, 4, v1
    v_lshl_add_u32 v2, v3, 3, v2
    s_lshl_b32 s3, s88, 5
    s_add_u32 s3, s3, 18304
    v_add_u32 v4, s3, v2
    v_and_b32 v2, 3, v1
    v_lshlrev_b32 v2, 2, v2
    v_add_u32 v7, 163728, v2
    s_cmp_eq_u32 s94, 0
    s_cbranch_scc1 L_HA
    s_waitcnt vmcnt(7)
    v_lshlrev_b32 v184, 16, v168
    v_and_b32 v185, 0xffff0000, v168
    v_lshlrev_b32 v186, 16, v169
    v_and_b32 v187, 0xffff0000, v169
    s_waitcnt vmcnt(6)
    v_lshlrev_b32 v188, 16, v170
    v_and_b32 v189, 0xffff0000, v170
    v_lshlrev_b32 v190, 16, v171
    v_and_b32 v191, 0xffff0000, v171
    s_waitcnt vmcnt(5)
    v_lshlrev_b32 v192, 16, v172
    v_and_b32 v193, 0xffff0000, v172
    v_lshlrev_b32 v194, 16, v173
    v_and_b32 v195, 0xffff0000, v173
    s_waitcnt vmcnt(4)
    v_lshlrev_b32 v196, 16, v174
    v_and_b32 v197, 0xffff0000, v174
    v_lshlrev_b32 v198, 16, v175
    v_and_b32 v199, 0xffff0000, v175
L_hp1_0:
    ds_read_b32 v8, v7
    s_waitcnt lgkmcnt(0)
    v_cmp_ge_u32 vcc, 0, v8
    s_nop 1
    s_cbranch_vccz L_hp1_0_go
    s_sleep 3
    s_branch L_hp1_0
L_hp1_0_go:
    ds_read_b64_tr_b16 v[32:33], v4 offset:0
    ds_read_b64_tr_b16 v[34:35], v4 offset:576
    ds_read_b64_tr_b16 v[36:37], v4 offset:1152
    ds_read_b64_tr_b16 v[38:39], v4 offset:1728
    s_waitcnt lgkmcnt(3)
    v_lshlrev_b32 v48, 16, v32
    v_and_b32 v49, 0xffff0000, v32
    v_mul_f32 v48, v48, v184
    v_mul_f32 v49, v49, v185
    v_cvt_pk_bf16_f32 v32, v48, v49
    v_lshlrev_b32 v50, 16, v33
    v_and_b32 v51, 0xffff0000, v33
    v_mul_f32 v50, v50, v186
    v_mul_f32 v51, v51, v187
    v_cvt_pk_bf16_f32 v33, v50, v51
    buffer_store_dwordx2 v[32:33], v5, s[44:47], s8 offen
    s_waitcnt lgkmcnt(2)
    v_lshlrev_b32 v52, 16, v34
    v_and_b32 v53, 0xffff0000, v34
    v_mul_f32 v52, v52, v188
    v_mul_f32 v53, v53, v189
    v_cvt_pk_bf16_f32 v34, v52, v53
    v_lshlrev_b32 v54, 16, v35
    v_and_b32 v55, 0xffff0000, v35
    v_mul_f32 v54, v54, v190
    v_mul_f32 v55, v55, v191
    v_cvt_pk_bf16_f32 v35, v54, v55
    buffer_store_dwordx2 v[34:35], v5, s[44:47], s9 offen
    s_waitcnt lgkmcnt(1)
    v_lshlrev_b32 v48, 16, v36
    v_and_b32 v49, 0xffff0000, v36
    v_mul_f32 v48, v48, v192
    v_mul_f32 v49, v49, v193
    v_cvt_pk_bf16_f32 v36, v48, v49
    v_lshlrev_b32 v50, 16, v37
    v_and_b32 v51, 0xffff0000, v37
    v_mul_f32 v50, v50, v194
    v_mul_f32 v51, v51, v195
    v_cvt_pk_bf16_f32 v37, v50, v51
    buffer_store_dwordx2 v[36:37], v5, s[44:47], s10 offen
    s_waitcnt lgkmcnt(0)
    v_lshlrev_b32 v52, 16, v38
    v_and_b32 v53, 0xffff0000, v38
    v_mul_f32 v52, v52, v196
    v_mul_f32 v53, v53, v197
    v_cvt_pk_bf16_f32 v38, v52, v53
    v_lshlrev_b32 v54, 16, v39
    v_and_b32 v55, 0xffff0000, v39
    v_mul_f32 v54, v54, v198
    v_mul_f32 v55, v55, v199
    v_cvt_pk_bf16_f32 v39, v54, v55
    buffer_store_dwordx2 v[38:39], v5, s[44:47], s11 offen
    s_waitcnt vmcnt(7)
    v_lshlrev_b32 v200, 16, v176
    v_and_b32 v201, 0xffff0000, v176
    v_lshlrev_b32 v202, 16, v177
    v_and_b32 v203, 0xffff0000, v177
L_hp1_1:
    ds_read_b32 v8, v7
    s_waitcnt lgkmcnt(0)
    v_cmp_ge_u32 vcc, 1, v8
    s_nop 1
    s_cbranch_vccz L_hp1_1_go
    s_sleep 4
    s_branch L_hp1_1
L_hp1_1_go:
    ds_read_b64_tr_b16 v[40:41], v4 offset:2304
    s_waitcnt lgkmcnt(0)
    v_lshlrev_b32 v48, 16, v40
    v_and_b32 v49, 0xffff0000, v40
    v_mul_f32 v48, v48, v200
    v_mul_f32 v49, v49, v201
    v_cvt_pk_bf16_f32 v40, v48, v49
    v_lshlrev_b32 v50, 16, v41
    v_and_b32 v51, 0xffff0000, v41
    v_mul_f32 v50, v50, v202
    v_mul_f32 v51, v51, v203
    v_cvt_pk_bf16_f32 v41, v50, v51
    buffer_store_dwordx2 v[40:41], v5, s[44:47], s12 offen
    s_waitcnt vmcnt(7)
    v_lshlrev_b32 v204, 16, v178
    v_and_b32 v205, 0xffff0000, v178
    v_lshlrev_b32 v206, 16, v179
    v_and_b32 v207, 0xffff0000, v179
L_hp1_2:
    ds_read_b32 v8, v7
    s_waitcnt lgkmcnt(0)
    v_cmp_ge_u32 vcc, 2, v8
    s_nop 1
    s_cbranch_vccz L_hp1_2_go
    s_sleep 1
    s_branch L_hp1_2
L_hp1_2_go:
    ds_read_b64_tr_b16 v[42:43], v4 offset:2880
    s_waitcnt lgkmcnt(0)
    v_lshlrev_b32 v52, 16, v42
    v_and_b32 v53, 0xffff0000, v42
    v_mul_f32 v52, v52, v204
    v_mul_f32 v53, v53, v205
    v_cvt_pk_bf16_f32 v42, v52, v53
    v_lshlrev_b32 v54, 16, v43
    v_and_b32 v55, 0xffff0000, v43
    v_mul_f32 v54, v54, v206
    v_mul_f32 v55, v55, v207
    v_cvt_pk_bf16_f32 v43, v54, v55
    buffer_store_dwordx2 v[42:43], v5, s[44:47], s13 offen
    s_waitcnt vmcnt(7)
    v_lshlrev_b32 v208, 16, v180
    v_and_b32 v209, 0xffff0000, v180
    v_lshlrev_b32 v210, 16, v181
    v_and_b32 v211, 0xffff0000, v181
L_hp1_3:
    ds_read_b32 v8, v7
    s_waitcnt lgkmcnt(0)
    v_cmp_ge_u32 vcc, 3, v8
    s_nop 1
    s_cbranch_vccz L_hp1_3_go
    s_sleep 1
    s_branch L_hp1_3
L_hp1_3_go:
    ds_read_b64_tr_b16 v[44:45], v4 offset:3456
    s_waitcnt lgkmcnt(0)
    v_lshlrev_b32 v48, 16, v44
    v_and_b32 v49, 0xffff0000, v44
    v_mul_f32 v48, v48, v208
    v_mul_f32 v49, v49, v209
    v_cvt_pk_bf16_f32 v44, v48, v49
    v_lshlrev_b32 v50, 16, v45
    v_and_b32 v51, 0xffff0000, v45
    v_mul_f32 v50, v50, v210
    v_mul_f32 v51, v51, v211
    v_cvt_pk_bf16_f32 v45, v50, v51
    buffer_store_dwordx2 v[44:45], v5, s[44:47], s14 offen
    s_waitcnt vmcnt(7)
    v_lshlrev_b32 v212, 16, v182
    v_and_b32 v213, 0xffff0000, v182
    v_lshlrev_b32 v214, 16, v183
    v_and_b32 v215, 0xffff0000, v183
L_hp1_4:
    ds_read_b32 v8, v7
    s_waitcnt lgkmcnt(0)
    v_cmp_ge_u32 vcc, 4, v8
    s_nop 1
    s_cbranch_vccz L_hp1_4_go
    s_sleep 1
    s_branch L_hp1_4
L_hp1_4_go:
    ds_read_b64_tr_b16 v[46:47], v4 offset:4032
    s_waitcnt lgkmcnt(0)
    v_lshlrev_b32 v52, 16, v46
    v_and_b32 v53, 0xffff0000, v46
    v_mul_f32 v52, v52, v212
    v_mul_f32 v53, v53, v213
    v_cvt_pk_bf16_f32 v46, v52, v53
    v_lshlrev_b32 v54, 16, v47
    v_and_b32 v55, 0xffff0000, v47
    v_mul_f32 v54, v54, v214
    v_mul_f32 v55, v55, v215
    v_cvt_pk_bf16_f32 v47, v54, v55
    buffer_store_dwordx2 v[46:47], v5, s[44:47], s15 offen
    s_endpgm
L_HA:
L_hp0_0:
    ds_read_b32 v8, v7
    s_waitcnt lgkmcnt(0)
    v_cmp_ge_u32 vcc, 0, v8
    s_nop 1
    s_cbranch_vccz L_hp0_0_go
    s_sleep 3
    s_branch L_hp0_0
L_hp0_0_go:
    ds_read_b64_tr_b16 v[32:33], v4 offset:0
    ds_read_b64_tr_b16 v[34:35], v4 offset:576
    ds_read_b64_tr_b16 v[36:37], v4 offset:1152
    ds_read_b64_tr_b16 v[38:39], v4 offset:1728
    s_waitcnt lgkmcnt(3)
    buffer_store_dwordx2 v[32:33], v5, s[44:47], s8 offen
    s_waitcnt lgkmcnt(2)
    buffer_store_dwordx2 v[34:35], v5, s[44:47], s9 offen
    s_waitcnt lgkmcnt(1)
    buffer_store_dwordx2 v[36:37], v5, s[44:47], s10 offen
    s_waitcnt lgkmcnt(0)
    buffer_store_dwordx2 v[38:39], v5, s[44:47], s11 offen
L_hp0_1:
    ds_read_b32 v8, v7
    s_waitcnt lgkmcnt(0)
    v_cmp_ge_u32 vcc, 1, v8
    s_nop 1
    s_cbranch_vccz L_hp0_1_go
    s_sleep 4
    s_branch L_hp0_1
L_hp0_1_go:
    ds_read_b64_tr_b16 v[40:41], v4 offset:2304
    s_waitcnt lgkmcnt(0)
    buffer_store_dwordx2 v[40:41], v5, s[44:47], s12 offen
L_hp0_2:
    ds_read_b32 v8, v7
    s_waitcnt lgkmcnt(0)
    v_cmp_ge_u32 vcc, 2, v8
    s_nop 1
    s_cbranch_vccz L_hp0_2_go
    s_sleep 1
    s_branch L_hp0_2
L_hp0_2_go:
    ds_read_b64_tr_b16 v[42:43], v4 offset:2880
    s_waitcnt lgkmcnt(0)
    buffer_store_dwordx2 v[42:43], v5, s[44:47], s13 offen
L_hp0_3:
    ds_read_b32 v8, v7
    s_waitcnt lgkmcnt(0)
    v_cmp_ge_u32 vcc, 3, v8
    s_nop 1
    s_cbranch_vccz L_hp0_3_go
    s_sleep 1
    s_branch L_hp0_3
L_hp0_3_go:
    ds_read_b64_tr_b16 v[44:45], v4 offset:3456
    s_waitcnt lgkmcnt(0)
    buffer_store_dwordx2 v[44:45], v5, s[44:47], s14 offen
L_hp0_4:
    ds_read_b32 v8, v7
    s_waitcnt lgkmcnt(0)
    v_cmp_ge_u32 vcc, 4, v8
    s_nop 1
    s_cbranch_vccz L_hp0_4_go
    s_sleep 1
    s_branch L_hp0_4
L_hp0_4_go:
    ds_read_b64_tr_b16 v[46:47], v4 offset:4032
    s_waitcnt lgkmcnt(0)
    buffer_store_dwordx2 v[46:47], v5, s[44:47], s15 offen
    s_endpgm
L_end:
    s_endpgm
L_codeend:
.section .rodata,"a"
.p2align 6
.amdhsa_kernel concat_heads__ssm_conv_s4d__ssm_conv_h3__prompt_kernel
  .amdhsa_next_free_vgpr 256
  .amdhsa_next_free_sgpr 102
  .amdhsa_accum_offset 256
  .amdhsa_group_segment_fixed_size 0
  .amdhsa_kernarg_size 128
  .amdhsa_user_sgpr_count 2
  .amdhsa_user_sgpr_kernarg_segment_ptr 1
  .amdhsa_system_sgpr_workgroup_id_x 1
  .amdhsa_float_denorm_mode_32 3
.end_amdhsa_kernel
```
